```python
import torch

def _softmax(x, axis=-1):
    return torch.softmax(x, dim=axis)
def _gelu(x):
    return torch.nn.functional.gelu(x, approximate="tanh")
def _silu(x):
    return torch.nn.functional.silu(x)
def _sigmoid(x):
    return torch.sigmoid(x)
def _layernorm(x, axis=-1, eps=1e-5):
    m = x.mean(dim=axis, keepdim=True)
    v = x.var(dim=axis, keepdim=True, unbiased=False)
    return (x - m) / torch.sqrt(v + eps)
def _scatter_add(tgt, idx, src, axis=0):
    return tgt.clone().index_add_(axis, idx, src)
def _segment_sum(src, seg, n):
    out = torch.zeros((n,) + src.shape[1:], dtype=src.dtype)
    return out.index_add_(0, seg, src)
def _pad(x, pw):
    flat = tuple(v for pair in reversed(pw) for v in pair)
    return torch.nn.functional.pad(x, flat)

kernel_name = 'standalone__weight_only_int_squeezellm__prompt'

def setup_inputs():

    _w = (lambda a: (lambda t: t.to(torch.bfloat16) if t.is_floating_point() else t)(torch.as_tensor(a)))
    B, S, D, F = 1, 2048, 1024, 3584
    bits = 3 if (2 <= 3 <= 4) else 4
    L = 2 ** bits
    qw = torch.randint(0, L, (D, F)).to(torch.int64)
    lut = (lambda *s: torch.randn(*s, dtype=torch.bfloat16) * 0.05)(L, F)
    return {
        "x": _w((lambda *s: torch.randn(*s, dtype=torch.bfloat16) * 0.05)(B, S, D)),
        "qw": _w(qw),
        "lut": _w(lut),
    }

def reference(x, qw, lut):
    w = (lambda x, i, axis: torch.take_along_dim(x, i, dim=axis))(lut, qw, axis=0)
    w = (lambda x, dt: x.to(dt))(w, x.dtype)
    return torch.einsum('bsd,df->bsf', x, w)
```

```asm
; @launch grid=(252,1,1) block=(512,1,1) lds=161600
.amdgcn_target "amdgcn-amd-amdhsa--gfx950"
.text
.globl standalone__weight_only_int_squeezellm__prompt_kernel
.p2align 8
.type standalone__weight_only_int_squeezellm__prompt_kernel,@function
standalone__weight_only_int_squeezellm__prompt_kernel:
    s_cmp_ge_u32 s2, 252
    s_cbranch_scc1 L_end
    s_load_dwordx4 s[36:39], s[0:1], 0
    s_load_dwordx4 s[40:43], s[0:1], 16
    s_load_dwordx4 s[60:63], s[0:1], 32
    v_lshrrev_b32 v1, 6, v0
    s_and_b32 s28, s2, 7
    s_lshr_b32 s29, s2, 3
    s_mul_i32 s30, s28, 31
    s_min_u32 s31, s28, 4
    s_add_u32 s30, s30, s31
    s_add_u32 s30, s30, s29
    s_mul_i32 s25, s30, 2341
    s_lshr_b32 s25, s25, 16
    s_mul_i32 s31, s25, 28
    s_sub_u32 s26, s30, s31
    s_memrealtime s[56:57]
    s_and_b32 s47, s25, 7
    v_readfirstlane_b32 s27, v1
    s_cmp_ge_u32 s27, 4
    s_cbranch_scc1 L_dma
    s_setprio 3
    v_mov_b32 v28, 0
    v_mov_b32 v29, 0
    v_mov_b32 v30, 0
    v_mov_b32 v31, 0
    v_mov_b32 v11, 131072
    ds_write_b128 v11, v[28:31]
    s_mov_b32 s22, 0x05010400
    s_mov_b32 s23, 0x07030602
    s_mov_b32 s46, 0x07070707
    v_and_b32 v7, 1, v0
    v_bfe_u32 v8, v0, 1, 3
    v_lshl_add_u32 v7, v7, 3, v8
    v_and_b32 v8, 0xf0, v0
    v_add_u32 v7, v7, v8
    s_lshl_b32 s28, s26, 16
    v_lshlrev_b32 v6, 4, v7
    v_add_u32 v6, s28, v6
    v_and_b32 v7, 15, v0
    v_lshrrev_b32 v9, 6, v0
    v_lshlrev_b32 v8, 6, v9
    v_lshl_add_u32 v8, v7, 2, v8
    s_lshl_b32 s28, s26, 8
    v_add_u32 v10, s28, v8
    s_waitcnt lgkmcnt(0)
    s_barrier
    s_mov_b32 s8, s62
    s_and_b32 s9, s63, 0xffff
    s_mov_b32 s10, 1842176
    s_mov_b32 s11, 0x00020000
    s_mov_b32 s12, s40
    s_and_b32 s13, s41, 0xffff
    s_mov_b32 s14, 57344
    s_mov_b32 s15, 0x00020000
    s_mov_b32 s52, s60
    s_and_b32 s53, s61, 0xffff
    s_mov_b32 s54, 256
    s_mov_b32 s55, 0x00020000
    s_mov_b32 s28, 0
    buffer_load_dword v76, v10, s[12:15], s28 offen
    s_mov_b32 s28, 7168
    buffer_load_dword v77, v10, s[12:15], s28 offen
    s_mov_b32 s28, 14336
    buffer_load_dword v78, v10, s[12:15], s28 offen
    s_mov_b32 s28, 21504
    buffer_load_dword v79, v10, s[12:15], s28 offen
    s_mov_b32 s28, 28672
    buffer_load_dword v80, v10, s[12:15], s28 offen
    s_mov_b32 s28, 35840
    buffer_load_dword v81, v10, s[12:15], s28 offen
    s_mov_b32 s28, 43008
    buffer_load_dword v82, v10, s[12:15], s28 offen
    s_mov_b32 s28, 50176
    buffer_load_dword v83, v10, s[12:15], s28 offen
    v_and_b32 v7, 15, v0
    v_bfe_u32 v8, v0, 4, 2
    v_bfe_u32 v9, v0, 1, 3
    v_xor_b32 v8, v8, v9
    v_lshlrev_b32 v7, 7, v7
    v_lshl_add_u32 v1, v8, 4, v7
    v_xor_b32 v8, 4, v8
    v_lshl_add_u32 v2, v8, 4, v7
    v_and_b32 v7, 15, v0
    v_bfe_u32 v8, v0, 4, 2
    v_lshrrev_b32 v9, 6, v0
    v_mul_u32_u24 v7, 272, v7
    v_lshl_add_u32 v7, v9, 6, v7
    v_lshl_add_u32 v5, v8, 4, v7
    v_mov_b32 v84, 0
    v_mov_b32 v85, 0
    v_mov_b32 v86, 0
    v_mov_b32 v87, 0
    v_mov_b32 v88, 0
    v_mov_b32 v89, 0
    v_mov_b32 v90, 0
    v_mov_b32 v91, 0
    v_mov_b32 v92, 0
    v_mov_b32 v93, 0
    v_mov_b32 v94, 0
    v_mov_b32 v95, 0
    v_mov_b32 v96, 0
    v_mov_b32 v97, 0
    v_mov_b32 v98, 0
    v_mov_b32 v99, 0
    v_mov_b32 v100, 0
    v_mov_b32 v101, 0
    v_mov_b32 v102, 0
    v_mov_b32 v103, 0
    v_mov_b32 v104, 0
    v_mov_b32 v105, 0
    v_mov_b32 v106, 0
    v_mov_b32 v107, 0
    v_mov_b32 v108, 0
    v_mov_b32 v109, 0
    v_mov_b32 v110, 0
    v_mov_b32 v111, 0
    v_mov_b32 v112, 0
    v_mov_b32 v113, 0
    v_mov_b32 v114, 0
    v_mov_b32 v115, 0
    v_mov_b32 v116, 0
    v_mov_b32 v117, 0
    v_mov_b32 v118, 0
    v_mov_b32 v119, 0
    v_mov_b32 v120, 0
    v_mov_b32 v121, 0
    v_mov_b32 v122, 0
    v_mov_b32 v123, 0
    v_mov_b32 v124, 0
    v_mov_b32 v125, 0
    v_mov_b32 v126, 0
    v_mov_b32 v127, 0
    v_mov_b32 v128, 0
    v_mov_b32 v129, 0
    v_mov_b32 v130, 0
    v_mov_b32 v131, 0
    v_mov_b32 v132, 0
    v_mov_b32 v133, 0
    v_mov_b32 v134, 0
    v_mov_b32 v135, 0
    v_mov_b32 v136, 0
    v_mov_b32 v137, 0
    v_mov_b32 v138, 0
    v_mov_b32 v139, 0
    v_mov_b32 v140, 0
    v_mov_b32 v141, 0
    v_mov_b32 v142, 0
    v_mov_b32 v143, 0
    v_mov_b32 v144, 0
    v_mov_b32 v145, 0
    v_mov_b32 v146, 0
    v_mov_b32 v147, 0
    v_mov_b32 v148, 0
    v_mov_b32 v149, 0
    v_mov_b32 v150, 0
    v_mov_b32 v151, 0
    v_mov_b32 v152, 0
    v_mov_b32 v153, 0
    v_mov_b32 v154, 0
    v_mov_b32 v155, 0
    v_mov_b32 v156, 0
    v_mov_b32 v157, 0
    v_mov_b32 v158, 0
    v_mov_b32 v159, 0
    v_mov_b32 v160, 0
    v_mov_b32 v161, 0
    v_mov_b32 v162, 0
    v_mov_b32 v163, 0
    v_mov_b32 v164, 0
    v_mov_b32 v165, 0
    v_mov_b32 v166, 0
    v_mov_b32 v167, 0
    v_mov_b32 v168, 0
    v_mov_b32 v169, 0
    v_mov_b32 v170, 0
    v_mov_b32 v171, 0
    v_mov_b32 v172, 0
    v_mov_b32 v173, 0
    v_mov_b32 v174, 0
    v_mov_b32 v175, 0
    v_mov_b32 v176, 0
    v_mov_b32 v177, 0
    v_mov_b32 v178, 0
    v_mov_b32 v179, 0
    v_mov_b32 v180, 0
    v_mov_b32 v181, 0
    v_mov_b32 v182, 0
    v_mov_b32 v183, 0
    v_mov_b32 v184, 0
    v_mov_b32 v185, 0
    v_mov_b32 v186, 0
    v_mov_b32 v187, 0
    v_mov_b32 v188, 0
    v_mov_b32 v189, 0
    v_mov_b32 v190, 0
    v_mov_b32 v191, 0
    v_mov_b32 v192, 0
    v_mov_b32 v193, 0
    v_mov_b32 v194, 0
    v_mov_b32 v195, 0
    s_waitcnt vmcnt(0)
    s_mov_b32 s32, 0x05040100
    s_mov_b32 s33, 0x07060302
    s_mov_b32 s28, 0x05010400
    v_perm_b32 v14, v77, v76, s28
    v_perm_b32 v15, v79, v78, s28
    v_perm_b32 v16, v81, v80, s28
    v_perm_b32 v17, v83, v82, s28
    v_perm_b32 v18, v15, v14, s32
    v_perm_b32 v20, v15, v14, s33
    v_perm_b32 v19, v17, v16, s32
    v_perm_b32 v21, v17, v16, s33
    s_mov_b32 s28, 0x07030602
    v_perm_b32 v14, v77, v76, s28
    v_perm_b32 v15, v79, v78, s28
    v_perm_b32 v16, v81, v80, s28
    v_perm_b32 v17, v83, v82, s28
    v_perm_b32 v22, v15, v14, s32
    v_perm_b32 v24, v15, v14, s33
    v_perm_b32 v23, v17, v16, s32
    v_perm_b32 v25, v17, v16, s33
    v_mov_b32 v76, 0
    v_mov_b32 v77, 0
    v_mov_b32 v78, 0
    v_mov_b32 v79, 0
    v_mov_b32 v80, 0
    v_mov_b32 v81, 0
    v_mov_b32 v82, 0
    v_mov_b32 v83, 0
    s_mov_b32 s35, 4294934528
    s_sub_u32 s56, s56, 800
    s_subb_u32 s57, s57, 0
    v_and_b32 v7, 31, v0
    s_lshl_b32 s28, s26, 8
    s_add_u32 s28, s28, 1835008
    v_lshl_add_u32 v7, v7, 3, s28
    s_mov_b32 s58, 0
    s_mov_b32 s32, 1000000
    v_mov_b32 v9, s57
    v_and_b32 v10, 0xfff, v6
    v_add_u32 v10, 131136, v10
    s_waitcnt lgkmcnt(0)
    s_add_u32 s35, s35, 32768
    s_cmp_eq_u32 s35, 131072
    s_cselect_b32 s35, 0, s35
    v_add_u32 v3, s35, v1
    s_barrier
    ds_read_b128 v[44:47], v10 offset:0
    ds_read_b128 v[48:51], v10 offset:4096
    s_waitcnt lgkmcnt(0)
    ds_read_b128 v[52:55], v3 offset:0
    ds_read_b128 v[56:59], v3 offset:2048
    ds_read_b128 v[60:63], v3 offset:4096
    ds_read_b128 v[64:67], v3 offset:6144
    v_and_b32 v12, s46, v44
    v_lshrrev_b32 v13, 4, v44
    v_perm_b32 v14, v19, v18, v12
    v_and_b32 v13, s46, v13
    v_perm_b32 v15, v21, v20, v12
    v_perm_b32 v16, v19, v18, v13
    v_perm_b32 v17, v21, v20, v13
    v_perm_b32 v28, v15, v14, s22
    v_perm_b32 v29, v15, v14, s23
    v_perm_b32 v30, v17, v16, s22
    v_perm_b32 v31, v17, v16, s23
    v_and_b32 v12, s46, v46
    v_lshrrev_b32 v13, 4, v46
    v_perm_b32 v14, v23, v22, v12
    v_and_b32 v13, s46, v13
    v_perm_b32 v15, v25, v24, v12
    v_perm_b32 v16, v23, v22, v13
    v_perm_b32 v17, v25, v24, v13
    v_perm_b32 v32, v15, v14, s22
    v_perm_b32 v33, v15, v14, s23
    v_perm_b32 v34, v17, v16, s22
    v_perm_b32 v35, v17, v16, s23
    s_nop 1
    s_waitcnt lgkmcnt(2)
    v_mfma_f32_16x16x32_bf16 v[76:79], v[28:31], v[52:55], v[76:79]
    ds_read_b128 v[68:71], v3 offset:8192
    v_mfma_f32_16x16x32_bf16 v[80:83], v[32:35], v[52:55], v[80:83]
    v_and_b32 v12, s46, v45
    v_mfma_f32_16x16x32_bf16 v[84:87], v[28:31], v[56:59], v[84:87]
    ds_read_b128 v[72:75], v3 offset:10240
    v_lshrrev_b32 v13, 4, v45
    v_mfma_f32_16x16x32_bf16 v[88:91], v[32:35], v[56:59], v[88:91]
    v_perm_b32 v14, v19, v18, v12
    s_waitcnt lgkmcnt(2)
    v_mfma_f32_16x16x32_bf16 v[92:95], v[28:31], v[60:63], v[92:95]
    ds_read_b128 v[52:55], v3 offset:12288
    v_and_b32 v13, s46, v13
    v_mfma_f32_16x16x32_bf16 v[96:99], v[32:35], v[60:63], v[96:99]
    v_perm_b32 v15, v21, v20, v12
    v_mfma_f32_16x16x32_bf16 v[100:103], v[28:31], v[64:67], v[100:103]
    ds_read_b128 v[56:59], v3 offset:14336
    v_mfma_f32_16x16x32_bf16 v[104:107], v[32:35], v[64:67], v[104:107]
    v_perm_b32 v16, v19, v18, v13
    s_waitcnt lgkmcnt(2)
    v_mfma_f32_16x16x32_bf16 v[108:111], v[28:31], v[68:71], v[108:111]
    ds_read_b128 v[60:63], v3 offset:16384
    v_perm_b32 v17, v21, v20, v13
    v_mfma_f32_16x16x32_bf16 v[112:115], v[32:35], v[68:71], v[112:115]
    v_perm_b32 v36, v15, v14, s22
    v_mfma_f32_16x16x32_bf16 v[116:119], v[28:31], v[72:75], v[116:119]
    ds_read_b128 v[64:67], v3 offset:18432
    v_perm_b32 v37, v15, v14, s23
    v_mfma_f32_16x16x32_bf16 v[120:123], v[32:35], v[72:75], v[120:123]
    v_perm_b32 v38, v17, v16, s22
    s_waitcnt lgkmcnt(2)
    v_mfma_f32_16x16x32_bf16 v[124:127], v[28:31], v[52:55], v[124:127]
    ds_read_b128 v[68:71], v3 offset:20480
    v_mfma_f32_16x16x32_bf16 v[128:131], v[32:35], v[52:55], v[128:131]
    v_perm_b32 v39, v17, v16, s23
    v_mfma_f32_16x16x32_bf16 v[132:135], v[28:31], v[56:59], v[132:135]
    ds_read_b128 v[72:75], v3 offset:22528
    v_and_b32 v12, s46, v47
    v_mfma_f32_16x16x32_bf16 v[136:139], v[32:35], v[56:59], v[136:139]
    v_lshrrev_b32 v13, 4, v47
    s_waitcnt lgkmcnt(2)
    v_mfma_f32_16x16x32_bf16 v[140:143], v[28:31], v[60:63], v[140:143]
    ds_read_b128 v[52:55], v3 offset:24576
    v_perm_b32 v14, v23, v22, v12
    v_mfma_f32_16x16x32_bf16 v[144:147], v[32:35], v[60:63], v[144:147]
    v_and_b32 v13, s46, v13
    v_mfma_f32_16x16x32_bf16 v[148:151], v[28:31], v[64:67], v[148:151]
    ds_read_b128 v[56:59], v3 offset:26624
    v_mfma_f32_16x16x32_bf16 v[152:155], v[32:35], v[64:67], v[152:155]
    v_perm_b32 v15, v25, v24, v12
    s_waitcnt lgkmcnt(2)
    v_mfma_f32_16x16x32_bf16 v[156:159], v[28:31], v[68:71], v[156:159]
    v_add_u32 v4, s35, v2
    ds_read_b128 v[60:63], v3 offset:28672
    v_mfma_f32_16x16x32_bf16 v[160:163], v[32:35], v[68:71], v[160:163]
    v_perm_b32 v16, v23, v22, v13
    v_perm_b32 v17, v25, v24, v13
    v_mfma_f32_16x16x32_bf16 v[164:167], v[28:31], v[72:75], v[164:167]
    ds_read_b128 v[64:67], v4 offset:0
    v_perm_b32 v40, v15, v14, s22
    v_mfma_f32_16x16x32_bf16 v[168:171], v[32:35], v[72:75], v[168:171]
    v_perm_b32 v41, v15, v14, s23
    s_waitcnt lgkmcnt(2)
    v_mfma_f32_16x16x32_bf16 v[172:175], v[28:31], v[52:55], v[172:175]
    ds_read_b128 v[68:71], v4 offset:2048
    v_perm_b32 v42, v17, v16, s22
    v_mfma_f32_16x16x32_bf16 v[176:179], v[32:35], v[52:55], v[176:179]
    v_perm_b32 v43, v17, v16, s23
    v_mfma_f32_16x16x32_bf16 v[180:183], v[28:31], v[56:59], v[180:183]
    ds_read_b128 v[72:75], v4 offset:4096
    v_mfma_f32_16x16x32_bf16 v[184:187], v[32:35], v[56:59], v[184:187]
    s_waitcnt lgkmcnt(2)
    v_mfma_f32_16x16x32_bf16 v[188:191], v[28:31], v[60:63], v[188:191]
    ds_read_b128 v[52:55], v4 offset:6144
    v_mfma_f32_16x16x32_bf16 v[192:195], v[32:35], v[60:63], v[192:195]
    v_mfma_f32_16x16x32_bf16 v[76:79], v[36:39], v[64:67], v[76:79]
    ds_read_b128 v[56:59], v4 offset:8192
    v_mfma_f32_16x16x32_bf16 v[80:83], v[40:43], v[64:67], v[80:83]
    s_waitcnt lgkmcnt(2)
    v_mfma_f32_16x16x32_bf16 v[84:87], v[36:39], v[68:71], v[84:87]
    ds_read_b128 v[60:63], v4 offset:10240
    v_and_b32 v12, s46, v48
    v_mfma_f32_16x16x32_bf16 v[88:91], v[40:43], v[68:71], v[88:91]
    v_lshrrev_b32 v13, 4, v48
    v_mfma_f32_16x16x32_bf16 v[92:95], v[36:39], v[72:75], v[92:95]
    ds_read_b128 v[64:67], v4 offset:12288
    v_perm_b32 v14, v19, v18, v12
    v_mfma_f32_16x16x32_bf16 v[96:99], v[40:43], v[72:75], v[96:99]
    v_and_b32 v13, s46, v13
    s_waitcnt lgkmcnt(2)
    v_mfma_f32_16x16x32_bf16 v[100:103], v[36:39], v[52:55], v[100:103]
    ds_read_b128 v[68:71], v4 offset:14336
    v_perm_b32 v15, v21, v20, v12
    v_mfma_f32_16x16x32_bf16 v[104:107], v[40:43], v[52:55], v[104:107]
    v_perm_b32 v16, v19, v18, v13
    v_mfma_f32_16x16x32_bf16 v[108:111], v[36:39], v[56:59], v[108:111]
    ds_read_b128 v[72:75], v4 offset:16384
    v_mfma_f32_16x16x32_bf16 v[112:115], v[40:43], v[56:59], v[112:115]
    v_perm_b32 v17, v21, v20, v13
    s_waitcnt lgkmcnt(2)
    v_mfma_f32_16x16x32_bf16 v[116:119], v[36:39], v[60:63], v[116:119]
    ds_read_b128 v[52:55], v4 offset:18432
    v_perm_b32 v28, v15, v14, s22
    v_mfma_f32_16x16x32_bf16 v[120:123], v[40:43], v[60:63], v[120:123]
    v_perm_b32 v29, v15, v14, s23
    v_mfma_f32_16x16x32_bf16 v[124:127], v[36:39], v[64:67], v[124:127]
    ds_read_b128 v[56:59], v4 offset:20480
    v_perm_b32 v30, v17, v16, s22
    v_mfma_f32_16x16x32_bf16 v[128:131], v[40:43], v[64:67], v[128:131]
    v_perm_b32 v31, v17, v16, s23
    s_waitcnt lgkmcnt(2)
    v_mfma_f32_16x16x32_bf16 v[132:135], v[36:39], v[68:71], v[132:135]
    ds_read_b128 v[60:63], v4 offset:22528
    v_and_b32 v12, s46, v50
    v_mfma_f32_16x16x32_bf16 v[136:139], v[40:43], v[68:71], v[136:139]
    v_lshrrev_b32 v13, 4, v50
    v_mfma_f32_16x16x32_bf16 v[140:143], v[36:39], v[72:75], v[140:143]
    ds_read_b128 v[64:67], v4 offset:24576
    v_mfma_f32_16x16x32_bf16 v[144:147], v[40:43], v[72:75], v[144:147]
    v_perm_b32 v14, v23, v22, v12
    s_waitcnt lgkmcnt(2)
    v_mfma_f32_16x16x32_bf16 v[148:151], v[36:39], v[52:55], v[148:151]
    ds_read_b128 v[68:71], v4 offset:26624
    v_and_b32 v13, s46, v13
    v_mfma_f32_16x16x32_bf16 v[152:155], v[40:43], v[52:55], v[152:155]
    v_perm_b32 v15, v25, v24, v12
    v_mfma_f32_16x16x32_bf16 v[156:159], v[36:39], v[56:59], v[156:159]
    ds_read_b128 v[72:75], v4 offset:28672
    v_perm_b32 v16, v23, v22, v13
    v_mfma_f32_16x16x32_bf16 v[160:163], v[40:43], v[56:59], v[160:163]
    v_perm_b32 v17, v25, v24, v13
    s_waitcnt lgkmcnt(0)
    s_add_u32 s35, s35, 32768
    s_cmp_eq_u32 s35, 131072
    s_cselect_b32 s35, 0, s35
    v_add_u32 v3, s35, v1
    s_barrier
    v_mfma_f32_16x16x32_bf16 v[164:167], v[36:39], v[60:63], v[164:167]
    ds_read_b128 v[52:55], v3 offset:0
    v_perm_b32 v32, v15, v14, s22
    v_mfma_f32_16x16x32_bf16 v[168:171], v[40:43], v[60:63], v[168:171]
    v_perm_b32 v33, v15, v14, s23
    v_mfma_f32_16x16x32_bf16 v[172:175], v[36:39], v[64:67], v[172:175]
    ds_read_b128 v[56:59], v3 offset:2048
    v_perm_b32 v34, v17, v16, s22
    v_mfma_f32_16x16x32_bf16 v[176:179], v[40:43], v[64:67], v[176:179]
    v_perm_b32 v35, v17, v16, s23
    v_mfma_f32_16x16x32_bf16 v[180:183], v[36:39], v[68:71], v[180:183]
    ds_read_b128 v[60:63], v3 offset:4096
    v_mfma_f32_16x16x32_bf16 v[184:187], v[40:43], v[68:71], v[184:187]
    v_mfma_f32_16x16x32_bf16 v[188:191], v[36:39], v[72:75], v[188:191]
    ds_read_b128 v[64:67], v3 offset:6144
    v_mfma_f32_16x16x32_bf16 v[192:195], v[40:43], v[72:75], v[192:195]
    s_waitcnt lgkmcnt(2)
    v_mfma_f32_16x16x32_bf16 v[76:79], v[28:31], v[52:55], v[76:79]
    ds_read_b128 v[68:71], v3 offset:8192
    v_mfma_f32_16x16x32_bf16 v[80:83], v[32:35], v[52:55], v[80:83]
    v_and_b32 v12, s46, v49
    v_mfma_f32_16x16x32_bf16 v[84:87], v[28:31], v[56:59], v[84:87]
    ds_read_b128 v[72:75], v3 offset:10240
    v_lshrrev_b32 v13, 4, v49
    v_mfma_f32_16x16x32_bf16 v[88:91], v[32:35], v[56:59], v[88:91]
    v_perm_b32 v14, v19, v18, v12
    s_waitcnt lgkmcnt(2)
    v_mfma_f32_16x16x32_bf16 v[92:95], v[28:31], v[60:63], v[92:95]
    ds_read_b128 v[52:55], v3 offset:12288
    v_and_b32 v13, s46, v13
    v_mfma_f32_16x16x32_bf16 v[96:99], v[32:35], v[60:63], v[96:99]
    v_perm_b32 v15, v21, v20, v12
    v_mfma_f32_16x16x32_bf16 v[100:103], v[28:31], v[64:67], v[100:103]
    ds_read_b128 v[56:59], v3 offset:14336
    v_mfma_f32_16x16x32_bf16 v[104:107], v[32:35], v[64:67], v[104:107]
    v_perm_b32 v16, v19, v18, v13
    s_waitcnt lgkmcnt(2)
    v_mfma_f32_16x16x32_bf16 v[108:111], v[28:31], v[68:71], v[108:111]
    ds_read_b128 v[60:63], v3 offset:16384
    v_perm_b32 v17, v21, v20, v13
    v_mfma_f32_16x16x32_bf16 v[112:115], v[32:35], v[68:71], v[112:115]
    v_perm_b32 v36, v15, v14, s22
    v_mfma_f32_16x16x32_bf16 v[116:119], v[28:31], v[72:75], v[116:119]
    ds_read_b128 v[64:67], v3 offset:18432
    v_perm_b32 v37, v15, v14, s23
    v_mfma_f32_16x16x32_bf16 v[120:123], v[32:35], v[72:75], v[120:123]
    v_perm_b32 v38, v17, v16, s22
    s_waitcnt lgkmcnt(2)
    v_mfma_f32_16x16x32_bf16 v[124:127], v[28:31], v[52:55], v[124:127]
    ds_read_b128 v[68:71], v3 offset:20480
    v_mfma_f32_16x16x32_bf16 v[128:131], v[32:35], v[52:55], v[128:131]
    v_perm_b32 v39, v17, v16, s23
    v_mfma_f32_16x16x32_bf16 v[132:135], v[28:31], v[56:59], v[132:135]
    ds_read_b128 v[72:75], v3 offset:22528
    v_and_b32 v12, s46, v51
    v_mfma_f32_16x16x32_bf16 v[136:139], v[32:35], v[56:59], v[136:139]
    v_lshrrev_b32 v13, 4, v51
    s_waitcnt lgkmcnt(2)
    v_mfma_f32_16x16x32_bf16 v[140:143], v[28:31], v[60:63], v[140:143]
    ds_read_b128 v[52:55], v3 offset:24576
    v_perm_b32 v14, v23, v22, v12
    v_mfma_f32_16x16x32_bf16 v[144:147], v[32:35], v[60:63], v[144:147]
    v_and_b32 v13, s46, v13
    v_mfma_f32_16x16x32_bf16 v[148:151], v[28:31], v[64:67], v[148:151]
    ds_read_b128 v[56:59], v3 offset:26624
    v_mfma_f32_16x16x32_bf16 v[152:155], v[32:35], v[64:67], v[152:155]
    v_perm_b32 v15, v25, v24, v12
    s_waitcnt lgkmcnt(2)
    v_mfma_f32_16x16x32_bf16 v[156:159], v[28:31], v[68:71], v[156:159]
    v_add_u32 v4, s35, v2
    ds_read_b128 v[60:63], v3 offset:28672
    v_mfma_f32_16x16x32_bf16 v[160:163], v[32:35], v[68:71], v[160:163]
    v_perm_b32 v16, v23, v22, v13
    v_perm_b32 v17, v25, v24, v13
    v_mfma_f32_16x16x32_bf16 v[164:167], v[28:31], v[72:75], v[164:167]
    ds_read_b128 v[64:67], v4 offset:0
    v_perm_b32 v40, v15, v14, s22
    v_mfma_f32_16x16x32_bf16 v[168:171], v[32:35], v[72:75], v[168:171]
    v_perm_b32 v41, v15, v14, s23
    s_waitcnt lgkmcnt(2)
    v_mfma_f32_16x16x32_bf16 v[172:175], v[28:31], v[52:55], v[172:175]
    ds_read_b128 v[68:71], v4 offset:2048
    v_perm_b32 v42, v17, v16, s22
    v_mfma_f32_16x16x32_bf16 v[176:179], v[32:35], v[52:55], v[176:179]
    v_perm_b32 v43, v17, v16, s23
    v_mfma_f32_16x16x32_bf16 v[180:183], v[28:31], v[56:59], v[180:183]
    ds_read_b128 v[72:75], v4 offset:4096
    v_mfma_f32_16x16x32_bf16 v[184:187], v[32:35], v[56:59], v[184:187]
    s_waitcnt lgkmcnt(2)
    v_mfma_f32_16x16x32_bf16 v[188:191], v[28:31], v[60:63], v[188:191]
    ds_read_b128 v[52:55], v4 offset:6144
    v_mfma_f32_16x16x32_bf16 v[192:195], v[32:35], v[60:63], v[192:195]
    v_mfma_f32_16x16x32_bf16 v[76:79], v[36:39], v[64:67], v[76:79]
    ds_read_b128 v[56:59], v4 offset:8192
    v_mfma_f32_16x16x32_bf16 v[80:83], v[40:43], v[64:67], v[80:83]
    buffer_load_dwordx2 v[198:199], v7, s[8:11], 0 offen sc0 sc1
    s_waitcnt lgkmcnt(2)
    v_mfma_f32_16x16x32_bf16 v[84:87], v[36:39], v[68:71], v[84:87]
    ds_read_b128 v[60:63], v4 offset:10240
    v_mfma_f32_16x16x32_bf16 v[88:91], v[40:43], v[68:71], v[88:91]
    v_mfma_f32_16x16x32_bf16 v[92:95], v[36:39], v[72:75], v[92:95]
    ds_read_b128 v[64:67], v4 offset:12288
    v_mfma_f32_16x16x32_bf16 v[96:99], v[40:43], v[72:75], v[96:99]
    s_waitcnt lgkmcnt(2)
    v_mfma_f32_16x16x32_bf16 v[100:103], v[36:39], v[52:55], v[100:103]
    ds_read_b128 v[68:71], v4 offset:14336
    v_mfma_f32_16x16x32_bf16 v[104:107], v[40:43], v[52:55], v[104:107]
    v_mfma_f32_16x16x32_bf16 v[108:111], v[36:39], v[56:59], v[108:111]
    ds_read_b128 v[72:75], v4 offset:16384
    v_mfma_f32_16x16x32_bf16 v[112:115], v[40:43], v[56:59], v[112:115]
    s_waitcnt lgkmcnt(2)
    v_mfma_f32_16x16x32_bf16 v[116:119], v[36:39], v[60:63], v[116:119]
    ds_read_b128 v[52:55], v4 offset:18432
    v_mfma_f32_16x16x32_bf16 v[120:123], v[40:43], v[60:63], v[120:123]
    v_mfma_f32_16x16x32_bf16 v[124:127], v[36:39], v[64:67], v[124:127]
    ds_read_b128 v[56:59], v4 offset:20480
    v_mfma_f32_16x16x32_bf16 v[128:131], v[40:43], v[64:67], v[128:131]
    s_waitcnt lgkmcnt(2)
    v_mfma_f32_16x16x32_bf16 v[132:135], v[36:39], v[68:71], v[132:135]
    ds_read_b128 v[60:63], v4 offset:22528
    v_mfma_f32_16x16x32_bf16 v[136:139], v[40:43], v[68:71], v[136:139]
    v_mfma_f32_16x16x32_bf16 v[140:143], v[36:39], v[72:75], v[140:143]
    ds_read_b128 v[64:67], v4 offset:24576
    v_mfma_f32_16x16x32_bf16 v[144:147], v[40:43], v[72:75], v[144:147]
    buffer_load_dwordx2 v[196:197], v7, s[8:11], 0 offen sc0 sc1
    s_waitcnt lgkmcnt(2)
    v_mfma_f32_16x16x32_bf16 v[148:151], v[36:39], v[52:55], v[148:151]
    ds_read_b128 v[68:71], v4 offset:26624
    v_mfma_f32_16x16x32_bf16 v[152:155], v[40:43], v[52:55], v[152:155]
    v_mfma_f32_16x16x32_bf16 v[156:159], v[36:39], v[56:59], v[156:159]
    ds_read_b128 v[72:75], v4 offset:28672
    v_mfma_f32_16x16x32_bf16 v[160:163], v[40:43], v[56:59], v[160:163]
    s_waitcnt lgkmcnt(0)
    s_add_u32 s35, s35, 32768
    s_cmp_eq_u32 s35, 131072
    s_cselect_b32 s35, 0, s35
    v_add_u32 v3, s35, v1
    s_barrier
    v_mfma_f32_16x16x32_bf16 v[164:167], v[36:39], v[60:63], v[164:167]
    ds_read_b128 v[52:55], v3 offset:0
    v_mfma_f32_16x16x32_bf16 v[168:171], v[40:43], v[60:63], v[168:171]
    v_mfma_f32_16x16x32_bf16 v[172:175], v[36:39], v[64:67], v[172:175]
    ds_read_b128 v[56:59], v3 offset:2048
    v_mfma_f32_16x16x32_bf16 v[176:179], v[40:43], v[64:67], v[176:179]
    v_mfma_f32_16x16x32_bf16 v[180:183], v[36:39], v[68:71], v[180:183]
    ds_read_b128 v[60:63], v3 offset:4096
    v_mfma_f32_16x16x32_bf16 v[184:187], v[40:43], v[68:71], v[184:187]
    v_mfma_f32_16x16x32_bf16 v[188:191], v[36:39], v[72:75], v[188:191]
    ds_read_b128 v[64:67], v3 offset:6144
    v_mfma_f32_16x16x32_bf16 v[192:195], v[40:43], v[72:75], v[192:195]
    s_waitcnt vmcnt(1)
    v_subrev_co_u32 v198, vcc, s56, v198
    s_nop 1
    v_subb_co_u32 v199, vcc, v199, v9, vcc
    v_cmp_le_u32 vcc, s32, v198
    v_cmp_ne_u32 s[30:31], 0, v199
    s_or_b64 vcc, vcc, s[30:31]
    s_cbranch_scc0 L_flags_ok
L_fchk:
    s_waitcnt vmcnt(0)
    v_subrev_co_u32 v196, vcc, s56, v196
    s_nop 1
    v_subb_co_u32 v197, vcc, v197, v9, vcc
    v_cmp_le_u32 vcc, s32, v196
    v_cmp_ne_u32 s[30:31], 0, v197
    s_or_b64 vcc, vcc, s[30:31]
    s_cbranch_scc0 L_flags_ok
    s_sleep 4
    buffer_load_dwordx2 v[196:197], v7, s[8:11], 0 offen sc0 sc1
    s_add_u32 s58, s58, 1
    s_cmp_lt_u32 s58, 3000
    s_cbranch_scc1 L_fchk
    v_mov_b32 v8, 1
    ds_write_b32 v11, v8 offset:8
    s_waitcnt lgkmcnt(0)
L_flags_ok:
    s_lshl_b32 s21, s47, 13
    s_add_u32 s21, s21, 4096
    s_add_u32 s21, s21, 4096
    s_and_b32 s21, s21, 0xffff
    buffer_load_dwordx4 v[44:47], v6, s[8:11], s21 offen sc0 sc1
    s_add_u32 s21, s21, 4096
    s_and_b32 s21, s21, 0xffff
    buffer_load_dwordx4 v[48:51], v6, s[8:11], s21 offen sc0 sc1
    s_barrier
    ds_read_b32 v8, v11 offset:8
    s_waitcnt lgkmcnt(0)
    v_readfirstlane_b32 s59, v8
    s_cmp_eq_u32 s59, 0
    s_cbranch_scc1 L_cgo
    s_barrier
    s_waitcnt vmcnt(0)
    s_lshl_b32 s21, s47, 13
    s_add_u32 s21, s21, 4096
    s_add_u32 s21, s21, 4096
    s_and_b32 s21, s21, 0xffff
    buffer_load_dwordx4 v[44:47], v6, s[8:11], s21 offen sc0 sc1
    s_add_u32 s21, s21, 4096
    s_and_b32 s21, s21, 0xffff
    buffer_load_dwordx4 v[48:51], v6, s[8:11], s21 offen sc0 sc1
L_cgo:
    s_waitcnt vmcnt(1)
    v_and_b32 v12, s46, v44
    v_lshrrev_b32 v13, 4, v44
    v_perm_b32 v14, v19, v18, v12
    v_and_b32 v13, s46, v13
    v_perm_b32 v15, v21, v20, v12
    v_perm_b32 v16, v19, v18, v13
    v_perm_b32 v17, v21, v20, v13
    v_perm_b32 v28, v15, v14, s22
    v_perm_b32 v29, v15, v14, s23
    v_perm_b32 v30, v17, v16, s22
    v_perm_b32 v31, v17, v16, s23
    v_and_b32 v12, s46, v46
    v_lshrrev_b32 v13, 4, v46
    v_perm_b32 v14, v23, v22, v12
    v_and_b32 v13, s46, v13
    v_perm_b32 v15, v25, v24, v12
    v_perm_b32 v16, v23, v22, v13
    v_perm_b32 v17, v25, v24, v13
    v_perm_b32 v32, v15, v14, s22
    v_perm_b32 v33, v15, v14, s23
    v_perm_b32 v34, v17, v16, s22
    v_perm_b32 v35, v17, v16, s23
    s_nop 1
    s_mov_b32 s24, 1
L_cloop:
    s_waitcnt lgkmcnt(2)
    v_mfma_f32_16x16x32_bf16 v[76:79], v[28:31], v[52:55], v[76:79]
    ds_read_b128 v[68:71], v3 offset:8192
    v_mfma_f32_16x16x32_bf16 v[80:83], v[32:35], v[52:55], v[80:83]
    v_and_b32 v12, s46, v45
    v_mfma_f32_16x16x32_bf16 v[84:87], v[28:31], v[56:59], v[84:87]
    ds_read_b128 v[72:75], v3 offset:10240
    v_lshrrev_b32 v13, 4, v45
    v_mfma_f32_16x16x32_bf16 v[88:91], v[32:35], v[56:59], v[88:91]
    v_perm_b32 v14, v19, v18, v12
    s_waitcnt lgkmcnt(2)
    v_mfma_f32_16x16x32_bf16 v[92:95], v[28:31], v[60:63], v[92:95]
    ds_read_b128 v[52:55], v3 offset:12288
    v_and_b32 v13, s46, v13
    v_mfma_f32_16x16x32_bf16 v[96:99], v[32:35], v[60:63], v[96:99]
    v_perm_b32 v15, v21, v20, v12
    v_mfma_f32_16x16x32_bf16 v[100:103], v[28:31], v[64:67], v[100:103]
    ds_read_b128 v[56:59], v3 offset:14336
    v_perm_b32 v16, v19, v18, v13
    v_mfma_f32_16x16x32_bf16 v[104:107], v[32:35], v[64:67], v[104:107]
    v_perm_b32 v17, v21, v20, v13
    s_waitcnt lgkmcnt(2)
    v_mfma_f32_16x16x32_bf16 v[108:111], v[28:31], v[68:71], v[108:111]
    ds_read_b128 v[60:63], v3 offset:16384
    v_mfma_f32_16x16x32_bf16 v[112:115], v[32:35], v[68:71], v[112:115]
    v_perm_b32 v36, v15, v14, s22
    v_mfma_f32_16x16x32_bf16 v[116:119], v[28:31], v[72:75], v[116:119]
    ds_read_b128 v[64:67], v3 offset:18432
    v_perm_b32 v37, v15, v14, s23
    v_mfma_f32_16x16x32_bf16 v[120:123], v[32:35], v[72:75], v[120:123]
    v_perm_b32 v38, v17, v16, s22
    s_waitcnt lgkmcnt(2)
    v_mfma_f32_16x16x32_bf16 v[124:127], v[28:31], v[52:55], v[124:127]
    ds_read_b128 v[68:71], v3 offset:20480
    v_perm_b32 v39, v17, v16, s23
    v_mfma_f32_16x16x32_bf16 v[128:131], v[32:35], v[52:55], v[128:131]
    v_and_b32 v12, s46, v47
    v_mfma_f32_16x16x32_bf16 v[132:135], v[28:31], v[56:59], v[132:135]
    ds_read_b128 v[72:75], v3 offset:22528
    v_lshrrev_b32 v13, 4, v47
    v_mfma_f32_16x16x32_bf16 v[136:139], v[32:35], v[56:59], v[136:139]
    v_perm_b32 v14, v23, v22, v12
    s_waitcnt lgkmcnt(2)
    v_mfma_f32_16x16x32_bf16 v[140:143], v[28:31], v[60:63], v[140:143]
    ds_read_b128 v[52:55], v3 offset:24576
    v_mfma_f32_16x16x32_bf16 v[144:147], v[32:35], v[60:63], v[144:147]
    v_and_b32 v13, s46, v13
    v_mfma_f32_16x16x32_bf16 v[148:151], v[28:31], v[64:67], v[148:151]
    ds_read_b128 v[56:59], v3 offset:26624
    v_perm_b32 v15, v25, v24, v12
    v_mfma_f32_16x16x32_bf16 v[152:155], v[32:35], v[64:67], v[152:155]
    v_perm_b32 v16, v23, v22, v13
    s_waitcnt lgkmcnt(2)
    v_mfma_f32_16x16x32_bf16 v[156:159], v[28:31], v[68:71], v[156:159]
    v_add_u32 v4, s35, v2
    ds_read_b128 v[60:63], v3 offset:28672
    v_mfma_f32_16x16x32_bf16 v[160:163], v[32:35], v[68:71], v[160:163]
    v_perm_b32 v17, v25, v24, v13
    v_perm_b32 v40, v15, v14, s22
    v_mfma_f32_16x16x32_bf16 v[164:167], v[28:31], v[72:75], v[164:167]
    ds_read_b128 v[64:67], v4 offset:0
    v_perm_b32 v41, v15, v14, s23
    v_mfma_f32_16x16x32_bf16 v[168:171], v[32:35], v[72:75], v[168:171]
    v_perm_b32 v42, v17, v16, s22
    s_waitcnt lgkmcnt(2)
    v_mfma_f32_16x16x32_bf16 v[172:175], v[28:31], v[52:55], v[172:175]
    ds_read_b128 v[68:71], v4 offset:2048
    v_perm_b32 v43, v17, v16, s23
    v_mfma_f32_16x16x32_bf16 v[176:179], v[32:35], v[52:55], v[176:179]
    s_add_u32 s21, s21, 4096
    s_and_b32 s21, s21, 0xffff
    buffer_load_dwordx4 v[44:47], v6, s[8:11], s21 offen sc0 sc1
    v_mfma_f32_16x16x32_bf16 v[180:183], v[28:31], v[56:59], v[180:183]
    ds_read_b128 v[72:75], v4 offset:4096
    v_mfma_f32_16x16x32_bf16 v[184:187], v[32:35], v[56:59], v[184:187]
    s_waitcnt lgkmcnt(2)
    v_mfma_f32_16x16x32_bf16 v[188:191], v[28:31], v[60:63], v[188:191]
    ds_read_b128 v[52:55], v4 offset:6144
    v_mfma_f32_16x16x32_bf16 v[192:195], v[32:35], v[60:63], v[192:195]
    v_mfma_f32_16x16x32_bf16 v[76:79], v[36:39], v[64:67], v[76:79]
    ds_read_b128 v[56:59], v4 offset:8192
    v_mfma_f32_16x16x32_bf16 v[80:83], v[40:43], v[64:67], v[80:83]
    s_waitcnt vmcnt(1)
    s_waitcnt lgkmcnt(2)
    v_mfma_f32_16x16x32_bf16 v[84:87], v[36:39], v[68:71], v[84:87]
    ds_read_b128 v[60:63], v4 offset:10240
    v_and_b32 v12, s46, v48
    v_mfma_f32_16x16x32_bf16 v[88:91], v[40:43], v[68:71], v[88:91]
    v_lshrrev_b32 v13, 4, v48
    v_mfma_f32_16x16x32_bf16 v[92:95], v[36:39], v[72:75], v[92:95]
    ds_read_b128 v[64:67], v4 offset:12288
    v_perm_b32 v14, v19, v18, v12
    v_mfma_f32_16x16x32_bf16 v[96:99], v[40:43], v[72:75], v[96:99]
    v_and_b32 v13, s46, v13
    s_waitcnt lgkmcnt(2)
    v_mfma_f32_16x16x32_bf16 v[100:103], v[36:39], v[52:55], v[100:103]
    ds_read_b128 v[68:71], v4 offset:14336
    v_perm_b32 v15, v21, v20, v12
    v_mfma_f32_16x16x32_bf16 v[104:107], v[40:43], v[52:55], v[104:107]
    v_perm_b32 v16, v19, v18, v13
    v_mfma_f32_16x16x32_bf16 v[108:111], v[36:39], v[56:59], v[108:111]
    ds_read_b128 v[72:75], v4 offset:16384
    v_mfma_f32_16x16x32_bf16 v[112:115], v[40:43], v[56:59], v[112:115]
    v_perm_b32 v17, v21, v20, v13
    s_waitcnt lgkmcnt(2)
    v_mfma_f32_16x16x32_bf16 v[116:119], v[36:39], v[60:63], v[116:119]
    ds_read_b128 v[52:55], v4 offset:18432
    v_perm_b32 v28, v15, v14, s22
    v_mfma_f32_16x16x32_bf16 v[120:123], v[40:43], v[60:63], v[120:123]
    v_perm_b32 v29, v15, v14, s23
    v_mfma_f32_16x16x32_bf16 v[124:127], v[36:39], v[64:67], v[124:127]
    ds_read_b128 v[56:59], v4 offset:20480
    v_perm_b32 v30, v17, v16, s22
    v_mfma_f32_16x16x32_bf16 v[128:131], v[40:43], v[64:67], v[128:131]
    v_perm_b32 v31, v17, v16, s23
    s_waitcnt lgkmcnt(2)
    v_mfma_f32_16x16x32_bf16 v[132:135], v[36:39], v[68:71], v[132:135]
    ds_read_b128 v[60:63], v4 offset:22528
    v_and_b32 v12, s46, v50
    v_mfma_f32_16x16x32_bf16 v[136:139], v[40:43], v[68:71], v[136:139]
    v_lshrrev_b32 v13, 4, v50
    v_mfma_f32_16x16x32_bf16 v[140:143], v[36:39], v[72:75], v[140:143]
    ds_read_b128 v[64:67], v4 offset:24576
    v_mfma_f32_16x16x32_bf16 v[144:147], v[40:43], v[72:75], v[144:147]
    v_perm_b32 v14, v23, v22, v12
    s_waitcnt lgkmcnt(2)
    v_mfma_f32_16x16x32_bf16 v[148:151], v[36:39], v[52:55], v[148:151]
    ds_read_b128 v[68:71], v4 offset:26624
    v_and_b32 v13, s46, v13
    v_mfma_f32_16x16x32_bf16 v[152:155], v[40:43], v[52:55], v[152:155]
    v_perm_b32 v15, v25, v24, v12
    v_mfma_f32_16x16x32_bf16 v[156:159], v[36:39], v[56:59], v[156:159]
    ds_read_b128 v[72:75], v4 offset:28672
    v_perm_b32 v16, v23, v22, v13
    v_mfma_f32_16x16x32_bf16 v[160:163], v[40:43], v[56:59], v[160:163]
    v_perm_b32 v17, v25, v24, v13
    s_waitcnt lgkmcnt(0)
    s_add_u32 s35, s35, 32768
    s_cmp_eq_u32 s35, 131072
    s_cselect_b32 s35, 0, s35
    v_add_u32 v3, s35, v1
    s_barrier
    v_mfma_f32_16x16x32_bf16 v[164:167], v[36:39], v[60:63], v[164:167]
    ds_read_b128 v[52:55], v3 offset:0
    v_perm_b32 v32, v15, v14, s22
    v_mfma_f32_16x16x32_bf16 v[168:171], v[40:43], v[60:63], v[168:171]
    v_perm_b32 v33, v15, v14, s23
    v_mfma_f32_16x16x32_bf16 v[172:175], v[36:39], v[64:67], v[172:175]
    ds_read_b128 v[56:59], v3 offset:2048
    v_perm_b32 v34, v17, v16, s22
    v_mfma_f32_16x16x32_bf16 v[176:179], v[40:43], v[64:67], v[176:179]
    v_perm_b32 v35, v17, v16, s23
    v_mfma_f32_16x16x32_bf16 v[180:183], v[36:39], v[68:71], v[180:183]
    ds_read_b128 v[60:63], v3 offset:4096
    v_mfma_f32_16x16x32_bf16 v[184:187], v[40:43], v[68:71], v[184:187]
    v_mfma_f32_16x16x32_bf16 v[188:191], v[36:39], v[72:75], v[188:191]
    ds_read_b128 v[64:67], v3 offset:6144
    v_mfma_f32_16x16x32_bf16 v[192:195], v[40:43], v[72:75], v[192:195]
    s_waitcnt lgkmcnt(2)
    v_mfma_f32_16x16x32_bf16 v[76:79], v[28:31], v[52:55], v[76:79]
    ds_read_b128 v[68:71], v3 offset:8192
    v_mfma_f32_16x16x32_bf16 v[80:83], v[32:35], v[52:55], v[80:83]
    v_and_b32 v12, s46, v49
    v_mfma_f32_16x16x32_bf16 v[84:87], v[28:31], v[56:59], v[84:87]
    ds_read_b128 v[72:75], v3 offset:10240
    v_lshrrev_b32 v13, 4, v49
    v_mfma_f32_16x16x32_bf16 v[88:91], v[32:35], v[56:59], v[88:91]
    v_perm_b32 v14, v19, v18, v12
    s_waitcnt lgkmcnt(2)
    v_mfma_f32_16x16x32_bf16 v[92:95], v[28:31], v[60:63], v[92:95]
    ds_read_b128 v[52:55], v3 offset:12288
    v_and_b32 v13, s46, v13
    v_mfma_f32_16x16x32_bf16 v[96:99], v[32:35], v[60:63], v[96:99]
    v_perm_b32 v15, v21, v20, v12
    v_mfma_f32_16x16x32_bf16 v[100:103], v[28:31], v[64:67], v[100:103]
    ds_read_b128 v[56:59], v3 offset:14336
    v_perm_b32 v16, v19, v18, v13
    v_mfma_f32_16x16x32_bf16 v[104:107], v[32:35], v[64:67], v[104:107]
    v_perm_b32 v17, v21, v20, v13
    s_waitcnt lgkmcnt(2)
    v_mfma_f32_16x16x32_bf16 v[108:111], v[28:31], v[68:71], v[108:111]
    ds_read_b128 v[60:63], v3 offset:16384
    v_mfma_f32_16x16x32_bf16 v[112:115], v[32:35], v[68:71], v[112:115]
    v_perm_b32 v36, v15, v14, s22
    v_mfma_f32_16x16x32_bf16 v[116:119], v[28:31], v[72:75], v[116:119]
    ds_read_b128 v[64:67], v3 offset:18432
    v_perm_b32 v37, v15, v14, s23
    v_mfma_f32_16x16x32_bf16 v[120:123], v[32:35], v[72:75], v[120:123]
    v_perm_b32 v38, v17, v16, s22
    s_waitcnt lgkmcnt(2)
    v_mfma_f32_16x16x32_bf16 v[124:127], v[28:31], v[52:55], v[124:127]
    ds_read_b128 v[68:71], v3 offset:20480
    v_perm_b32 v39, v17, v16, s23
    v_mfma_f32_16x16x32_bf16 v[128:131], v[32:35], v[52:55], v[128:131]
    v_and_b32 v12, s46, v51
    v_mfma_f32_16x16x32_bf16 v[132:135], v[28:31], v[56:59], v[132:135]
    ds_read_b128 v[72:75], v3 offset:22528
    v_lshrrev_b32 v13, 4, v51
    v_mfma_f32_16x16x32_bf16 v[136:139], v[32:35], v[56:59], v[136:139]
    v_perm_b32 v14, v23, v22, v12
    s_waitcnt lgkmcnt(2)
    v_mfma_f32_16x16x32_bf16 v[140:143], v[28:31], v[60:63], v[140:143]
    ds_read_b128 v[52:55], v3 offset:24576
    v_mfma_f32_16x16x32_bf16 v[144:147], v[32:35], v[60:63], v[144:147]
    v_and_b32 v13, s46, v13
    v_mfma_f32_16x16x32_bf16 v[148:151], v[28:31], v[64:67], v[148:151]
    ds_read_b128 v[56:59], v3 offset:26624
    v_perm_b32 v15, v25, v24, v12
    v_mfma_f32_16x16x32_bf16 v[152:155], v[32:35], v[64:67], v[152:155]
    v_perm_b32 v16, v23, v22, v13
    s_waitcnt lgkmcnt(2)
    v_mfma_f32_16x16x32_bf16 v[156:159], v[28:31], v[68:71], v[156:159]
    v_add_u32 v4, s35, v2
    ds_read_b128 v[60:63], v3 offset:28672
    v_mfma_f32_16x16x32_bf16 v[160:163], v[32:35], v[68:71], v[160:163]
    v_perm_b32 v17, v25, v24, v13
    v_perm_b32 v40, v15, v14, s22
    v_mfma_f32_16x16x32_bf16 v[164:167], v[28:31], v[72:75], v[164:167]
    ds_read_b128 v[64:67], v4 offset:0
    v_perm_b32 v41, v15, v14, s23
    v_mfma_f32_16x16x32_bf16 v[168:171], v[32:35], v[72:75], v[168:171]
    v_perm_b32 v42, v17, v16, s22
    s_waitcnt lgkmcnt(2)
    v_mfma_f32_16x16x32_bf16 v[172:175], v[28:31], v[52:55], v[172:175]
    ds_read_b128 v[68:71], v4 offset:2048
    v_perm_b32 v43, v17, v16, s23
    v_mfma_f32_16x16x32_bf16 v[176:179], v[32:35], v[52:55], v[176:179]
    s_add_u32 s21, s21, 4096
    s_and_b32 s21, s21, 0xffff
    buffer_load_dwordx4 v[48:51], v6, s[8:11], s21 offen sc0 sc1
    v_mfma_f32_16x16x32_bf16 v[180:183], v[28:31], v[56:59], v[180:183]
    ds_read_b128 v[72:75], v4 offset:4096
    v_mfma_f32_16x16x32_bf16 v[184:187], v[32:35], v[56:59], v[184:187]
    s_waitcnt lgkmcnt(2)
    v_mfma_f32_16x16x32_bf16 v[188:191], v[28:31], v[60:63], v[188:191]
    ds_read_b128 v[52:55], v4 offset:6144
    v_mfma_f32_16x16x32_bf16 v[192:195], v[32:35], v[60:63], v[192:195]
    v_mfma_f32_16x16x32_bf16 v[76:79], v[36:39], v[64:67], v[76:79]
    ds_read_b128 v[56:59], v4 offset:8192
    v_mfma_f32_16x16x32_bf16 v[80:83], v[40:43], v[64:67], v[80:83]
    s_waitcnt vmcnt(1)
    s_waitcnt lgkmcnt(2)
    v_mfma_f32_16x16x32_bf16 v[84:87], v[36:39], v[68:71], v[84:87]
    ds_read_b128 v[60:63], v4 offset:10240
    v_and_b32 v12, s46, v44
    v_mfma_f32_16x16x32_bf16 v[88:91], v[40:43], v[68:71], v[88:91]
    v_lshrrev_b32 v13, 4, v44
    v_mfma_f32_16x16x32_bf16 v[92:95], v[36:39], v[72:75], v[92:95]
    ds_read_b128 v[64:67], v4 offset:12288
    v_perm_b32 v14, v19, v18, v12
    v_mfma_f32_16x16x32_bf16 v[96:99], v[40:43], v[72:75], v[96:99]
    v_and_b32 v13, s46, v13
    s_waitcnt lgkmcnt(2)
    v_mfma_f32_16x16x32_bf16 v[100:103], v[36:39], v[52:55], v[100:103]
    ds_read_b128 v[68:71], v4 offset:14336
    v_perm_b32 v15, v21, v20, v12
    v_mfma_f32_16x16x32_bf16 v[104:107], v[40:43], v[52:55], v[104:107]
    v_perm_b32 v16, v19, v18, v13
    v_mfma_f32_16x16x32_bf16 v[108:111], v[36:39], v[56:59], v[108:111]
    ds_read_b128 v[72:75], v4 offset:16384
    v_mfma_f32_16x16x32_bf16 v[112:115], v[40:43], v[56:59], v[112:115]
    v_perm_b32 v17, v21, v20, v13
    s_waitcnt lgkmcnt(2)
    v_mfma_f32_16x16x32_bf16 v[116:119], v[36:39], v[60:63], v[116:119]
    ds_read_b128 v[52:55], v4 offset:18432
    v_perm_b32 v28, v15, v14, s22
    v_mfma_f32_16x16x32_bf16 v[120:123], v[40:43], v[60:63], v[120:123]
    v_perm_b32 v29, v15, v14, s23
    v_mfma_f32_16x16x32_bf16 v[124:127], v[36:39], v[64:67], v[124:127]
    ds_read_b128 v[56:59], v4 offset:20480
    v_perm_b32 v30, v17, v16, s22
    v_mfma_f32_16x16x32_bf16 v[128:131], v[40:43], v[64:67], v[128:131]
    v_perm_b32 v31, v17, v16, s23
    s_waitcnt lgkmcnt(2)
    v_mfma_f32_16x16x32_bf16 v[132:135], v[36:39], v[68:71], v[132:135]
    ds_read_b128 v[60:63], v4 offset:22528
    v_and_b32 v12, s46, v46
    v_mfma_f32_16x16x32_bf16 v[136:139], v[40:43], v[68:71], v[136:139]
    v_lshrrev_b32 v13, 4, v46
    v_mfma_f32_16x16x32_bf16 v[140:143], v[36:39], v[72:75], v[140:143]
    ds_read_b128 v[64:67], v4 offset:24576
    v_mfma_f32_16x16x32_bf16 v[144:147], v[40:43], v[72:75], v[144:147]
    v_perm_b32 v14, v23, v22, v12
    s_waitcnt lgkmcnt(2)
    v_mfma_f32_16x16x32_bf16 v[148:151], v[36:39], v[52:55], v[148:151]
    ds_read_b128 v[68:71], v4 offset:26624
    v_and_b32 v13, s46, v13
    v_mfma_f32_16x16x32_bf16 v[152:155], v[40:43], v[52:55], v[152:155]
    v_perm_b32 v15, v25, v24, v12
    v_mfma_f32_16x16x32_bf16 v[156:159], v[36:39], v[56:59], v[156:159]
    ds_read_b128 v[72:75], v4 offset:28672
    v_perm_b32 v16, v23, v22, v13
    v_mfma_f32_16x16x32_bf16 v[160:163], v[40:43], v[56:59], v[160:163]
    v_perm_b32 v17, v25, v24, v13
    s_waitcnt lgkmcnt(0)
    s_add_u32 s35, s35, 32768
    s_cmp_eq_u32 s35, 131072
    s_cselect_b32 s35, 0, s35
    v_add_u32 v3, s35, v1
    s_barrier
    v_mfma_f32_16x16x32_bf16 v[164:167], v[36:39], v[60:63], v[164:167]
    ds_read_b128 v[52:55], v3 offset:0
    v_perm_b32 v32, v15, v14, s22
    v_mfma_f32_16x16x32_bf16 v[168:171], v[40:43], v[60:63], v[168:171]
    v_perm_b32 v33, v15, v14, s23
    v_mfma_f32_16x16x32_bf16 v[172:175], v[36:39], v[64:67], v[172:175]
    ds_read_b128 v[56:59], v3 offset:2048
    v_perm_b32 v34, v17, v16, s22
    v_mfma_f32_16x16x32_bf16 v[176:179], v[40:43], v[64:67], v[176:179]
    v_perm_b32 v35, v17, v16, s23
    v_mfma_f32_16x16x32_bf16 v[180:183], v[36:39], v[68:71], v[180:183]
    ds_read_b128 v[60:63], v3 offset:4096
    v_mfma_f32_16x16x32_bf16 v[184:187], v[40:43], v[68:71], v[184:187]
    v_mfma_f32_16x16x32_bf16 v[188:191], v[36:39], v[72:75], v[188:191]
    ds_read_b128 v[64:67], v3 offset:6144
    v_mfma_f32_16x16x32_bf16 v[192:195], v[40:43], v[72:75], v[192:195]
    s_add_u32 s24, s24, 1
    s_cmp_eq_u32 s24, 5
    s_cbranch_scc0 L_c5
    s_lshl_b32 s28, s47, 13
    s_add_u32 s28, s28, 57344
    s_and_b32 s28, s28, 0xffff
    buffer_load_dwordx4 v[244:247], v6, s[8:11], s28 offen sc0 sc1
    s_lshl_b32 s28, s47, 13
    s_add_u32 s28, s28, 61440
    s_and_b32 s28, s28, 0xffff
    buffer_load_dwordx4 v[248:251], v6, s[8:11], s28 offen sc0 sc1
L_c5:
    s_cmp_lt_u32 s24, 6
    s_cbranch_scc1 L_cloop
    s_waitcnt lgkmcnt(2)
    v_mfma_f32_16x16x32_bf16 v[76:79], v[28:31], v[52:55], v[76:79]
    v_add_u32 v3, 65536, v1
    v_add_u32 v4, 65536, v2
    ds_read_b128 v[68:71], v1 offset:8192
    v_mfma_f32_16x16x32_bf16 v[80:83], v[32:35], v[52:55], v[80:83]
    v_and_b32 v12, s46, v45
    v_lshrrev_b32 v13, 4, v45
    v_perm_b32 v14, v19, v18, v12
    v_mfma_f32_16x16x32_bf16 v[84:87], v[28:31], v[56:59], v[84:87]
    v_add_u32 v7, 131136, v5
    v_add_u32 v8, 65536, v5
    ds_read_b128 v[72:75], v1 offset:10240
    v_and_b32 v13, s46, v13
    v_mfma_f32_16x16x32_bf16 v[88:91], v[32:35], v[56:59], v[88:91]
    v_perm_b32 v15, v21, v20, v12
    v_perm_b32 v16, v19, v18, v13
    v_perm_b32 v17, v21, v20, v13
    s_waitcnt lgkmcnt(2)
    v_mfma_f32_16x16x32_bf16 v[92:95], v[28:31], v[60:63], v[92:95]
    ds_read_b128 v[52:55], v1 offset:12288
    v_perm_b32 v36, v15, v14, s22
    v_perm_b32 v37, v15, v14, s23
    v_mfma_f32_16x16x32_bf16 v[96:99], v[32:35], v[60:63], v[96:99]
    v_perm_b32 v38, v17, v16, s22
    v_perm_b32 v39, v17, v16, s23
    v_mfma_f32_16x16x32_bf16 v[100:103], v[28:31], v[64:67], v[100:103]
    ds_read_b128 v[56:59], v2 offset:0
    v_and_b32 v12, s46, v47
    v_mfma_f32_16x16x32_bf16 v[104:107], v[32:35], v[64:67], v[104:107]
    v_lshrrev_b32 v13, 4, v47
    v_perm_b32 v14, v23, v22, v12
    s_waitcnt lgkmcnt(2)
    v_mfma_f32_16x16x32_bf16 v[108:111], v[28:31], v[68:71], v[108:111]
    ds_read_b128 v[60:63], v2 offset:2048
    v_and_b32 v13, s46, v13
    v_perm_b32 v15, v25, v24, v12
    v_mfma_f32_16x16x32_bf16 v[112:115], v[32:35], v[68:71], v[112:115]
    v_perm_b32 v16, v23, v22, v13
    v_perm_b32 v17, v25, v24, v13
    v_mfma_f32_16x16x32_bf16 v[116:119], v[28:31], v[72:75], v[116:119]
    ds_read_b128 v[64:67], v2 offset:4096
    v_perm_b32 v40, v15, v14, s22
    v_perm_b32 v41, v15, v14, s23
    v_mfma_f32_16x16x32_bf16 v[120:123], v[32:35], v[72:75], v[120:123]
    v_perm_b32 v42, v17, v16, s22
    v_perm_b32 v43, v17, v16, s23
    s_waitcnt lgkmcnt(2)
    v_mfma_f32_16x16x32_bf16 v[124:127], v[28:31], v[52:55], v[124:127]
    ds_read_b128 v[68:71], v2 offset:6144
    v_mfma_f32_16x16x32_bf16 v[128:131], v[32:35], v[52:55], v[128:131]
    v_mfma_f32_16x16x32_bf16 v[76:79], v[36:39], v[56:59], v[76:79]
    ds_read_b128 v[72:75], v2 offset:8192
    s_waitcnt vmcnt(0)
    v_mfma_f32_16x16x32_bf16 v[80:83], v[40:43], v[56:59], v[80:83]
    v_and_b32 v12, s46, v48
    v_lshrrev_b32 v13, 4, v48
    s_waitcnt lgkmcnt(2)
    v_mfma_f32_16x16x32_bf16 v[84:87], v[36:39], v[60:63], v[84:87]
    ds_read_b128 v[52:55], v2 offset:10240
    v_perm_b32 v14, v19, v18, v12
    v_and_b32 v13, s46, v13
    v_mfma_f32_16x16x32_bf16 v[88:91], v[40:43], v[60:63], v[88:91]
    v_perm_b32 v15, v21, v20, v12
    v_perm_b32 v16, v19, v18, v13
    v_mfma_f32_16x16x32_bf16 v[92:95], v[36:39], v[64:67], v[92:95]
    ds_read_b128 v[56:59], v2 offset:12288
    v_perm_b32 v17, v21, v20, v13
    v_perm_b32 v196, v15, v14, s22
    v_mfma_f32_16x16x32_bf16 v[96:99], v[40:43], v[64:67], v[96:99]
    v_perm_b32 v197, v15, v14, s23
    v_perm_b32 v198, v17, v16, s22
    s_barrier
    s_waitcnt lgkmcnt(2)
    v_mfma_f32_16x16x32_bf16 v[100:103], v[36:39], v[68:71], v[100:103]
    ds_read_b128 v[60:63], v1 offset:32768
    v_perm_b32 v199, v17, v16, s23
    v_and_b32 v12, s46, v50
    v_mfma_f32_16x16x32_bf16 v[104:107], v[40:43], v[68:71], v[104:107]
    v_lshrrev_b32 v13, 4, v50
    v_perm_b32 v14, v23, v22, v12
    v_mfma_f32_16x16x32_bf16 v[108:111], v[36:39], v[72:75], v[108:111]
    ds_read_b128 v[64:67], v1 offset:34816
    v_and_b32 v13, s46, v13
    v_perm_b32 v15, v25, v24, v12
    v_mfma_f32_16x16x32_bf16 v[112:115], v[40:43], v[72:75], v[112:115]
    v_perm_b32 v16, v23, v22, v13
    v_perm_b32 v17, v25, v24, v13
    s_waitcnt lgkmcnt(2)
    v_mfma_f32_16x16x32_bf16 v[116:119], v[36:39], v[52:55], v[116:119]
    ds_read_b128 v[68:71], v1 offset:36864
    v_perm_b32 v200, v15, v14, s22
    v_perm_b32 v201, v15, v14, s23
    v_mfma_f32_16x16x32_bf16 v[120:123], v[40:43], v[52:55], v[120:123]
    v_perm_b32 v202, v17, v16, s22
    v_perm_b32 v203, v17, v16, s23
    v_mfma_f32_16x16x32_bf16 v[124:127], v[36:39], v[56:59], v[124:127]
    ds_read_b128 v[72:75], v1 offset:38912
    v_mfma_f32_16x16x32_bf16 v[128:131], v[40:43], v[56:59], v[128:131]
    s_waitcnt lgkmcnt(2)
    v_mfma_f32_16x16x32_bf16 v[76:79], v[196:199], v[60:63], v[76:79]
    ds_read_b128 v[52:55], v1 offset:40960
    v_and_b32 v12, s46, v49
    v_mfma_f32_16x16x32_bf16 v[80:83], v[200:203], v[60:63], v[80:83]
    v_lshrrev_b32 v13, 4, v49
    v_perm_b32 v14, v19, v18, v12
    v_mfma_f32_16x16x32_bf16 v[84:87], v[196:199], v[64:67], v[84:87]
    ds_read_b128 v[56:59], v1 offset:43008
    v_and_b32 v13, s46, v13
    v_perm_b32 v15, v21, v20, v12
    v_mfma_f32_16x16x32_bf16 v[88:91], v[200:203], v[64:67], v[88:91]
    v_perm_b32 v16, v19, v18, v13
    v_perm_b32 v17, v21, v20, v13
    s_waitcnt lgkmcnt(2)
    v_mfma_f32_16x16x32_bf16 v[92:95], v[196:199], v[68:71], v[92:95]
    ds_read_b128 v[60:63], v1 offset:45056
    v_perm_b32 v204, v15, v14, s22
    v_perm_b32 v205, v15, v14, s23
    v_mfma_f32_16x16x32_bf16 v[96:99], v[200:203], v[68:71], v[96:99]
    v_perm_b32 v206, v17, v16, s22
    v_perm_b32 v207, v17, v16, s23
    v_mfma_f32_16x16x32_bf16 v[100:103], v[196:199], v[72:75], v[100:103]
    ds_read_b128 v[64:67], v2 offset:32768
    v_and_b32 v12, s46, v51
    v_mfma_f32_16x16x32_bf16 v[104:107], v[200:203], v[72:75], v[104:107]
    v_lshrrev_b32 v13, 4, v51
    v_perm_b32 v14, v23, v22, v12
    s_waitcnt lgkmcnt(2)
    v_mfma_f32_16x16x32_bf16 v[108:111], v[196:199], v[52:55], v[108:111]
    ds_read_b128 v[68:71], v2 offset:34816
    v_and_b32 v13, s46, v13
    v_perm_b32 v15, v25, v24, v12
    v_mfma_f32_16x16x32_bf16 v[112:115], v[200:203], v[52:55], v[112:115]
    v_perm_b32 v16, v23, v22, v13
    v_perm_b32 v17, v25, v24, v13
    v_mfma_f32_16x16x32_bf16 v[116:119], v[196:199], v[56:59], v[116:119]
    ds_read_b128 v[72:75], v2 offset:36864
    v_perm_b32 v208, v15, v14, s22
    v_perm_b32 v209, v15, v14, s23
    v_mfma_f32_16x16x32_bf16 v[120:123], v[200:203], v[56:59], v[120:123]
    v_perm_b32 v210, v17, v16, s22
    v_perm_b32 v211, v17, v16, s23
    s_waitcnt lgkmcnt(2)
    v_mfma_f32_16x16x32_bf16 v[124:127], v[196:199], v[60:63], v[124:127]
    ds_read_b128 v[52:55], v2 offset:38912
    v_mfma_f32_16x16x32_bf16 v[128:131], v[200:203], v[60:63], v[128:131]
    v_mfma_f32_16x16x32_bf16 v[76:79], v[204:207], v[64:67], v[76:79]
    ds_read_b128 v[56:59], v2 offset:40960
    v_mfma_f32_16x16x32_bf16 v[80:83], v[208:211], v[64:67], v[80:83]
    v_and_b32 v12, s46, v244
    v_lshrrev_b32 v13, 4, v244
    s_waitcnt lgkmcnt(2)
    v_mfma_f32_16x16x32_bf16 v[84:87], v[204:207], v[68:71], v[84:87]
    ds_read_b128 v[60:63], v2 offset:43008
    v_perm_b32 v14, v19, v18, v12
    v_and_b32 v13, s46, v13
    v_mfma_f32_16x16x32_bf16 v[88:91], v[208:211], v[68:71], v[88:91]
    v_perm_b32 v15, v21, v20, v12
    v_perm_b32 v16, v19, v18, v13
    v_mfma_f32_16x16x32_bf16 v[92:95], v[204:207], v[72:75], v[92:95]
    ds_read_b128 v[64:67], v2 offset:45056
    v_perm_b32 v17, v21, v20, v13
    v_perm_b32 v212, v15, v14, s22
    v_mfma_f32_16x16x32_bf16 v[96:99], v[208:211], v[72:75], v[96:99]
    v_perm_b32 v213, v15, v14, s23
    v_perm_b32 v214, v17, v16, s22
    s_barrier
    s_waitcnt lgkmcnt(2)
    v_mfma_f32_16x16x32_bf16 v[100:103], v[204:207], v[52:55], v[100:103]
    ds_read_b128 v[68:71], v3 offset:0
    v_perm_b32 v215, v17, v16, s23
    v_and_b32 v12, s46, v246
    v_mfma_f32_16x16x32_bf16 v[104:107], v[208:211], v[52:55], v[104:107]
    v_lshrrev_b32 v13, 4, v246
    v_perm_b32 v14, v23, v22, v12
    v_mfma_f32_16x16x32_bf16 v[108:111], v[204:207], v[56:59], v[108:111]
    ds_read_b128 v[72:75], v3 offset:2048
    v_and_b32 v13, s46, v13
    v_perm_b32 v15, v25, v24, v12
    v_mfma_f32_16x16x32_bf16 v[112:115], v[208:211], v[56:59], v[112:115]
    v_perm_b32 v16, v23, v22, v13
    v_perm_b32 v17, v25, v24, v13
    s_waitcnt lgkmcnt(2)
    v_mfma_f32_16x16x32_bf16 v[116:119], v[204:207], v[60:63], v[116:119]
    ds_read_b128 v[52:55], v3 offset:4096
    v_perm_b32 v216, v15, v14, s22
    v_perm_b32 v217, v15, v14, s23
    v_mfma_f32_16x16x32_bf16 v[120:123], v[208:211], v[60:63], v[120:123]
    v_perm_b32 v218, v17, v16, s22
    v_perm_b32 v219, v17, v16, s23
    v_mfma_f32_16x16x32_bf16 v[124:127], v[204:207], v[64:67], v[124:127]
    ds_read_b128 v[56:59], v3 offset:6144
    v_mfma_f32_16x16x32_bf16 v[128:131], v[208:211], v[64:67], v[128:131]
    s_waitcnt lgkmcnt(2)
    v_mfma_f32_16x16x32_bf16 v[76:79], v[212:215], v[68:71], v[76:79]
    ds_read_b128 v[60:63], v3 offset:8192
    v_and_b32 v12, s46, v245
    v_mfma_f32_16x16x32_bf16 v[80:83], v[216:219], v[68:71], v[80:83]
    v_lshrrev_b32 v13, 4, v245
    v_perm_b32 v14, v19, v18, v12
    v_mfma_f32_16x16x32_bf16 v[84:87], v[212:215], v[72:75], v[84:87]
    ds_read_b128 v[64:67], v3 offset:10240
    v_and_b32 v13, s46, v13
    v_perm_b32 v15, v21, v20, v12
    v_mfma_f32_16x16x32_bf16 v[88:91], v[216:219], v[72:75], v[88:91]
    v_perm_b32 v16, v19, v18, v13
    v_perm_b32 v17, v21, v20, v13
    s_waitcnt lgkmcnt(2)
    v_mfma_f32_16x16x32_bf16 v[92:95], v[212:215], v[52:55], v[92:95]
    ds_read_b128 v[68:71], v3 offset:12288
    v_perm_b32 v220, v15, v14, s22
    v_perm_b32 v221, v15, v14, s23
    v_mfma_f32_16x16x32_bf16 v[96:99], v[216:219], v[52:55], v[96:99]
    v_perm_b32 v222, v17, v16, s22
    v_perm_b32 v223, v17, v16, s23
    v_mfma_f32_16x16x32_bf16 v[100:103], v[212:215], v[56:59], v[100:103]
    ds_read_b128 v[72:75], v4 offset:0
    v_and_b32 v12, s46, v247
    v_mfma_f32_16x16x32_bf16 v[104:107], v[216:219], v[56:59], v[104:107]
    v_lshrrev_b32 v13, 4, v247
    v_perm_b32 v14, v23, v22, v12
    s_waitcnt lgkmcnt(2)
    v_mfma_f32_16x16x32_bf16 v[108:111], v[212:215], v[60:63], v[108:111]
    ds_read_b128 v[52:55], v4 offset:2048
    v_and_b32 v13, s46, v13
    v_perm_b32 v15, v25, v24, v12
    v_mfma_f32_16x16x32_bf16 v[112:115], v[216:219], v[60:63], v[112:115]
    v_perm_b32 v16, v23, v22, v13
    v_perm_b32 v17, v25, v24, v13
    v_mfma_f32_16x16x32_bf16 v[116:119], v[212:215], v[64:67], v[116:119]
    ds_read_b128 v[56:59], v4 offset:4096
    v_perm_b32 v224, v15, v14, s22
    v_perm_b32 v225, v15, v14, s23
    v_mfma_f32_16x16x32_bf16 v[120:123], v[216:219], v[64:67], v[120:123]
    v_perm_b32 v226, v17, v16, s22
    v_perm_b32 v227, v17, v16, s23
    s_waitcnt lgkmcnt(2)
    v_mfma_f32_16x16x32_bf16 v[124:127], v[212:215], v[68:71], v[124:127]
    ds_read_b128 v[60:63], v4 offset:6144
    v_mfma_f32_16x16x32_bf16 v[128:131], v[216:219], v[68:71], v[128:131]
    v_mfma_f32_16x16x32_bf16 v[76:79], v[220:223], v[72:75], v[76:79]
    ds_read_b128 v[64:67], v4 offset:8192
    v_mfma_f32_16x16x32_bf16 v[80:83], v[224:227], v[72:75], v[80:83]
    v_and_b32 v12, s46, v248
    v_lshrrev_b32 v13, 4, v248
    s_waitcnt lgkmcnt(2)
    v_mfma_f32_16x16x32_bf16 v[84:87], v[220:223], v[52:55], v[84:87]
    ds_read_b128 v[68:71], v4 offset:10240
    v_perm_b32 v14, v19, v18, v12
    v_and_b32 v13, s46, v13
    v_mfma_f32_16x16x32_bf16 v[88:91], v[224:227], v[52:55], v[88:91]
    v_perm_b32 v15, v21, v20, v12
    v_perm_b32 v16, v19, v18, v13
    v_mfma_f32_16x16x32_bf16 v[92:95], v[220:223], v[56:59], v[92:95]
    ds_read_b128 v[72:75], v4 offset:12288
    v_perm_b32 v17, v21, v20, v13
    v_perm_b32 v228, v15, v14, s22
    v_mfma_f32_16x16x32_bf16 v[96:99], v[224:227], v[56:59], v[96:99]
    v_perm_b32 v229, v15, v14, s23
    v_perm_b32 v230, v17, v16, s22
    s_barrier
    s_waitcnt lgkmcnt(2)
    v_mfma_f32_16x16x32_bf16 v[100:103], v[220:223], v[60:63], v[100:103]
    ds_read_b128 v[52:55], v3 offset:32768
    v_perm_b32 v231, v17, v16, s23
    v_and_b32 v12, s46, v250
    v_mfma_f32_16x16x32_bf16 v[104:107], v[224:227], v[60:63], v[104:107]
    v_lshrrev_b32 v13, 4, v250
    v_perm_b32 v14, v23, v22, v12
    v_mfma_f32_16x16x32_bf16 v[108:111], v[220:223], v[64:67], v[108:111]
    ds_read_b128 v[56:59], v3 offset:34816
    v_and_b32 v13, s46, v13
    v_perm_b32 v15, v25, v24, v12
    v_mfma_f32_16x16x32_bf16 v[112:115], v[224:227], v[64:67], v[112:115]
    v_perm_b32 v16, v23, v22, v13
    v_perm_b32 v17, v25, v24, v13
    s_waitcnt lgkmcnt(2)
    v_mfma_f32_16x16x32_bf16 v[116:119], v[220:223], v[68:71], v[116:119]
    ds_read_b128 v[60:63], v3 offset:36864
    v_perm_b32 v232, v15, v14, s22
    v_perm_b32 v233, v15, v14, s23
    v_mfma_f32_16x16x32_bf16 v[120:123], v[224:227], v[68:71], v[120:123]
    v_perm_b32 v234, v17, v16, s22
    v_perm_b32 v235, v17, v16, s23
    v_mfma_f32_16x16x32_bf16 v[124:127], v[220:223], v[72:75], v[124:127]
    ds_read_b128 v[64:67], v3 offset:38912
    v_mfma_f32_16x16x32_bf16 v[128:131], v[224:227], v[72:75], v[128:131]
    s_waitcnt lgkmcnt(2)
    v_mfma_f32_16x16x32_bf16 v[76:79], v[228:231], v[52:55], v[76:79]
    ds_read_b128 v[68:71], v3 offset:40960
    v_and_b32 v12, s46, v249
    v_mfma_f32_16x16x32_bf16 v[80:83], v[232:235], v[52:55], v[80:83]
    v_lshrrev_b32 v13, 4, v249
    v_perm_b32 v14, v19, v18, v12
    v_mfma_f32_16x16x32_bf16 v[84:87], v[228:231], v[56:59], v[84:87]
    ds_read_b128 v[72:75], v3 offset:43008
    v_and_b32 v13, s46, v13
    v_perm_b32 v15, v21, v20, v12
    v_mfma_f32_16x16x32_bf16 v[88:91], v[232:235], v[56:59], v[88:91]
    v_perm_b32 v16, v19, v18, v13
    v_perm_b32 v17, v21, v20, v13
    s_waitcnt lgkmcnt(2)
    v_mfma_f32_16x16x32_bf16 v[92:95], v[228:231], v[60:63], v[92:95]
    ds_read_b128 v[52:55], v3 offset:45056
    v_perm_b32 v236, v15, v14, s22
    v_perm_b32 v237, v15, v14, s23
    v_mfma_f32_16x16x32_bf16 v[96:99], v[232:235], v[60:63], v[96:99]
    v_perm_b32 v238, v17, v16, s22
    v_perm_b32 v239, v17, v16, s23
    v_mfma_f32_16x16x32_bf16 v[100:103], v[228:231], v[64:67], v[100:103]
    ds_read_b128 v[56:59], v4 offset:32768
    v_and_b32 v12, s46, v251
    v_mfma_f32_16x16x32_bf16 v[104:107], v[232:235], v[64:67], v[104:107]
    v_lshrrev_b32 v13, 4, v251
    v_perm_b32 v14, v23, v22, v12
    s_waitcnt lgkmcnt(2)
    v_mfma_f32_16x16x32_bf16 v[108:111], v[228:231], v[68:71], v[108:111]
    ds_read_b128 v[60:63], v4 offset:34816
    v_and_b32 v13, s46, v13
    v_perm_b32 v15, v25, v24, v12
    v_mfma_f32_16x16x32_bf16 v[112:115], v[232:235], v[68:71], v[112:115]
    v_perm_b32 v16, v23, v22, v13
    v_perm_b32 v17, v25, v24, v13
    v_mfma_f32_16x16x32_bf16 v[116:119], v[228:231], v[72:75], v[116:119]
    ds_read_b128 v[64:67], v4 offset:36864
    v_perm_b32 v240, v15, v14, s22
    v_perm_b32 v241, v15, v14, s23
    v_mfma_f32_16x16x32_bf16 v[120:123], v[232:235], v[72:75], v[120:123]
    v_perm_b32 v242, v17, v16, s22
    v_perm_b32 v243, v17, v16, s23
    s_waitcnt lgkmcnt(2)
    v_mfma_f32_16x16x32_bf16 v[124:127], v[228:231], v[52:55], v[124:127]
    ds_read_b128 v[68:71], v4 offset:38912
    v_mfma_f32_16x16x32_bf16 v[128:131], v[232:235], v[52:55], v[128:131]
    v_mfma_f32_16x16x32_bf16 v[76:79], v[236:239], v[56:59], v[76:79]
    ds_read_b128 v[72:75], v4 offset:40960
    v_mfma_f32_16x16x32_bf16 v[80:83], v[240:243], v[56:59], v[80:83]
    s_waitcnt lgkmcnt(2)
    v_mfma_f32_16x16x32_bf16 v[84:87], v[236:239], v[60:63], v[84:87]
    ds_read_b128 v[52:55], v4 offset:43008
    v_mfma_f32_16x16x32_bf16 v[88:91], v[240:243], v[60:63], v[88:91]
    v_mfma_f32_16x16x32_bf16 v[92:95], v[236:239], v[64:67], v[92:95]
    ds_read_b128 v[56:59], v4 offset:45056
    v_mfma_f32_16x16x32_bf16 v[96:99], v[240:243], v[64:67], v[96:99]
    s_waitcnt lgkmcnt(2)
    v_mfma_f32_16x16x32_bf16 v[100:103], v[236:239], v[68:71], v[100:103]
    ds_read_b128 v[60:63], v1 offset:14336
    v_mfma_f32_16x16x32_bf16 v[104:107], v[240:243], v[68:71], v[104:107]
    v_mfma_f32_16x16x32_bf16 v[108:111], v[236:239], v[72:75], v[108:111]
    ds_read_b128 v[64:67], v1 offset:16384
    v_mfma_f32_16x16x32_bf16 v[112:115], v[240:243], v[72:75], v[112:115]
    s_waitcnt lgkmcnt(2)
    v_mfma_f32_16x16x32_bf16 v[116:119], v[236:239], v[52:55], v[116:119]
    ds_read_b128 v[68:71], v1 offset:18432
    v_mfma_f32_16x16x32_bf16 v[120:123], v[240:243], v[52:55], v[120:123]
    v_mfma_f32_16x16x32_bf16 v[124:127], v[236:239], v[56:59], v[124:127]
    ds_read_b128 v[72:75], v1 offset:20480
    v_mfma_f32_16x16x32_bf16 v[128:131], v[240:243], v[56:59], v[128:131]
    s_waitcnt lgkmcnt(2)
    v_mfma_f32_16x16x32_bf16 v[132:135], v[28:31], v[60:63], v[132:135]
    ds_read_b128 v[52:55], v2 offset:14336
    v_mfma_f32_16x16x32_bf16 v[136:139], v[32:35], v[60:63], v[136:139]
    v_mfma_f32_16x16x32_bf16 v[140:143], v[28:31], v[64:67], v[140:143]
    ds_read_b128 v[56:59], v2 offset:16384
    v_mfma_f32_16x16x32_bf16 v[144:147], v[32:35], v[64:67], v[144:147]
    v_cvt_pk_bf16_f32 v14, v76, v80
    s_waitcnt lgkmcnt(2)
    v_mfma_f32_16x16x32_bf16 v[148:151], v[28:31], v[68:71], v[148:151]
    ds_read_b128 v[60:63], v2 offset:18432
    v_cvt_pk_bf16_f32 v15, v77, v81
    v_mfma_f32_16x16x32_bf16 v[152:155], v[32:35], v[68:71], v[152:155]
    v_cvt_pk_bf16_f32 v16, v78, v82
    v_mfma_f32_16x16x32_bf16 v[156:159], v[28:31], v[72:75], v[156:159]
    ds_read_b128 v[64:67], v2 offset:20480
    v_cvt_pk_bf16_f32 v17, v79, v83
    v_mfma_f32_16x16x32_bf16 v[160:163], v[32:35], v[72:75], v[160:163]
    ds_write_b128 v7, v[14:17] offset:0
    s_waitcnt lgkmcnt(3)
    v_mfma_f32_16x16x32_bf16 v[132:135], v[36:39], v[52:55], v[132:135]
    ds_read_b128 v[68:71], v1 offset:47104
    v_cvt_pk_bf16_f32 v244, v84, v88
    v_mfma_f32_16x16x32_bf16 v[136:139], v[40:43], v[52:55], v[136:139]
    v_cvt_pk_bf16_f32 v245, v85, v89
    v_mfma_f32_16x16x32_bf16 v[140:143], v[36:39], v[56:59], v[140:143]
    ds_read_b128 v[72:75], v1 offset:49152
    v_cvt_pk_bf16_f32 v246, v86, v90
    v_mfma_f32_16x16x32_bf16 v[144:147], v[40:43], v[56:59], v[144:147]
    v_cvt_pk_bf16_f32 v247, v87, v91
    s_waitcnt lgkmcnt(3)
    v_mfma_f32_16x16x32_bf16 v[148:151], v[36:39], v[60:63], v[148:151]
    ds_read_b128 v[52:55], v1 offset:51200
    ds_write_b128 v7, v[244:247] offset:4352
    v_mfma_f32_16x16x32_bf16 v[152:155], v[40:43], v[60:63], v[152:155]
    v_cvt_pk_bf16_f32 v14, v92, v96
    v_mfma_f32_16x16x32_bf16 v[156:159], v[36:39], v[64:67], v[156:159]
    ds_read_b128 v[56:59], v1 offset:53248
    v_cvt_pk_bf16_f32 v15, v93, v97
    v_mfma_f32_16x16x32_bf16 v[160:163], v[40:43], v[64:67], v[160:163]
    v_cvt_pk_bf16_f32 v16, v94, v98
    s_waitcnt lgkmcnt(3)
    v_mfma_f32_16x16x32_bf16 v[132:135], v[196:199], v[68:71], v[132:135]
    ds_read_b128 v[60:63], v2 offset:47104
    v_cvt_pk_bf16_f32 v17, v95, v99
    v_mfma_f32_16x16x32_bf16 v[136:139], v[200:203], v[68:71], v[136:139]
    ds_write_b128 v7, v[14:17] offset:8704
    v_mfma_f32_16x16x32_bf16 v[140:143], v[196:199], v[72:75], v[140:143]
    ds_read_b128 v[64:67], v2 offset:49152
    v_cvt_pk_bf16_f32 v244, v100, v104
    v_mfma_f32_16x16x32_bf16 v[144:147], v[200:203], v[72:75], v[144:147]
    v_cvt_pk_bf16_f32 v245, v101, v105
    s_waitcnt lgkmcnt(3)
    v_mfma_f32_16x16x32_bf16 v[148:151], v[196:199], v[52:55], v[148:151]
    ds_read_b128 v[68:71], v2 offset:51200
    v_cvt_pk_bf16_f32 v246, v102, v106
    v_mfma_f32_16x16x32_bf16 v[152:155], v[200:203], v[52:55], v[152:155]
    v_cvt_pk_bf16_f32 v247, v103, v107
    v_mfma_f32_16x16x32_bf16 v[156:159], v[196:199], v[56:59], v[156:159]
    ds_read_b128 v[72:75], v2 offset:53248
    ds_write_b128 v7, v[244:247] offset:13056
    v_mfma_f32_16x16x32_bf16 v[160:163], v[200:203], v[56:59], v[160:163]
    v_cvt_pk_bf16_f32 v14, v108, v112
    s_waitcnt lgkmcnt(3)
    v_mfma_f32_16x16x32_bf16 v[132:135], v[204:207], v[60:63], v[132:135]
    ds_read_b128 v[52:55], v3 offset:14336
    v_cvt_pk_bf16_f32 v15, v109, v113
    v_mfma_f32_16x16x32_bf16 v[136:139], v[208:211], v[60:63], v[136:139]
    v_cvt_pk_bf16_f32 v16, v110, v114
    v_mfma_f32_16x16x32_bf16 v[140:143], v[204:207], v[64:67], v[140:143]
    ds_read_b128 v[56:59], v3 offset:16384
    v_cvt_pk_bf16_f32 v17, v111, v115
    v_mfma_f32_16x16x32_bf16 v[144:147], v[208:211], v[64:67], v[144:147]
    ds_write_b128 v7, v[14:17] offset:17408
    s_waitcnt lgkmcnt(4)
    v_mfma_f32_16x16x32_bf16 v[148:151], v[204:207], v[68:71], v[148:151]
    ds_read_b128 v[60:63], v3 offset:18432
    v_cvt_pk_bf16_f32 v244, v116, v120
    v_mfma_f32_16x16x32_bf16 v[152:155], v[208:211], v[68:71], v[152:155]
    v_cvt_pk_bf16_f32 v245, v117, v121
    v_mfma_f32_16x16x32_bf16 v[156:159], v[204:207], v[72:75], v[156:159]
    ds_read_b128 v[64:67], v3 offset:20480
    v_cvt_pk_bf16_f32 v246, v118, v122
    v_mfma_f32_16x16x32_bf16 v[160:163], v[208:211], v[72:75], v[160:163]
    v_cvt_pk_bf16_f32 v247, v119, v123
    s_waitcnt lgkmcnt(3)
    v_mfma_f32_16x16x32_bf16 v[132:135], v[212:215], v[52:55], v[132:135]
    ds_read_b128 v[68:71], v4 offset:14336
    ds_write_b128 v7, v[244:247] offset:21760
    v_mfma_f32_16x16x32_bf16 v[136:139], v[216:219], v[52:55], v[136:139]
    v_cvt_pk_bf16_f32 v14, v124, v128
    v_mfma_f32_16x16x32_bf16 v[140:143], v[212:215], v[56:59], v[140:143]
    ds_read_b128 v[72:75], v4 offset:16384
    v_cvt_pk_bf16_f32 v15, v125, v129
    v_mfma_f32_16x16x32_bf16 v[144:147], v[216:219], v[56:59], v[144:147]
    v_cvt_pk_bf16_f32 v16, v126, v130
    s_waitcnt lgkmcnt(3)
    v_mfma_f32_16x16x32_bf16 v[148:151], v[212:215], v[60:63], v[148:151]
    ds_read_b128 v[52:55], v4 offset:18432
    v_cvt_pk_bf16_f32 v17, v127, v131
    v_mfma_f32_16x16x32_bf16 v[152:155], v[216:219], v[60:63], v[152:155]
    ds_write_b128 v7, v[14:17] offset:26112
    v_mfma_f32_16x16x32_bf16 v[156:159], v[212:215], v[64:67], v[156:159]
    ds_read_b128 v[56:59], v4 offset:20480
    v_mfma_f32_16x16x32_bf16 v[160:163], v[216:219], v[64:67], v[160:163]
    s_waitcnt lgkmcnt(0)
    s_barrier
    v_mfma_f32_16x16x32_bf16 v[132:135], v[220:223], v[68:71], v[132:135]
    ds_read_b128 v[60:63], v3 offset:47104
    v_mfma_f32_16x16x32_bf16 v[136:139], v[224:227], v[68:71], v[136:139]
    v_mfma_f32_16x16x32_bf16 v[140:143], v[220:223], v[72:75], v[140:143]
    ds_read_b128 v[64:67], v3 offset:49152
    v_mfma_f32_16x16x32_bf16 v[144:147], v[224:227], v[72:75], v[144:147]
    v_mfma_f32_16x16x32_bf16 v[148:151], v[220:223], v[52:55], v[148:151]
    ds_read_b128 v[68:71], v3 offset:51200
    v_mfma_f32_16x16x32_bf16 v[152:155], v[224:227], v[52:55], v[152:155]
    v_mfma_f32_16x16x32_bf16 v[156:159], v[220:223], v[56:59], v[156:159]
    ds_read_b128 v[72:75], v3 offset:53248
    v_mfma_f32_16x16x32_bf16 v[160:163], v[224:227], v[56:59], v[160:163]
    s_waitcnt lgkmcnt(2)
    v_mfma_f32_16x16x32_bf16 v[132:135], v[228:231], v[60:63], v[132:135]
    ds_read_b128 v[52:55], v4 offset:47104
    v_mfma_f32_16x16x32_bf16 v[136:139], v[232:235], v[60:63], v[136:139]
    v_mfma_f32_16x16x32_bf16 v[140:143], v[228:231], v[64:67], v[140:143]
    ds_read_b128 v[56:59], v4 offset:49152
    v_mfma_f32_16x16x32_bf16 v[144:147], v[232:235], v[64:67], v[144:147]
    s_waitcnt lgkmcnt(2)
    v_mfma_f32_16x16x32_bf16 v[148:151], v[228:231], v[68:71], v[148:151]
    ds_read_b128 v[60:63], v4 offset:51200
    v_mfma_f32_16x16x32_bf16 v[152:155], v[232:235], v[68:71], v[152:155]
    v_mfma_f32_16x16x32_bf16 v[156:159], v[228:231], v[72:75], v[156:159]
    ds_read_b128 v[64:67], v4 offset:53248
    v_mfma_f32_16x16x32_bf16 v[160:163], v[232:235], v[72:75], v[160:163]
    s_waitcnt lgkmcnt(2)
    v_mfma_f32_16x16x32_bf16 v[132:135], v[236:239], v[52:55], v[132:135]
    ds_read_b128 v[68:71], v1 offset:22528
    v_mfma_f32_16x16x32_bf16 v[136:139], v[240:243], v[52:55], v[136:139]
    v_mfma_f32_16x16x32_bf16 v[140:143], v[236:239], v[56:59], v[140:143]
    ds_read_b128 v[72:75], v1 offset:24576
    v_mfma_f32_16x16x32_bf16 v[144:147], v[240:243], v[56:59], v[144:147]
    s_waitcnt lgkmcnt(2)
    v_mfma_f32_16x16x32_bf16 v[148:151], v[236:239], v[60:63], v[148:151]
    ds_read_b128 v[52:55], v1 offset:26624
    v_mfma_f32_16x16x32_bf16 v[152:155], v[240:243], v[60:63], v[152:155]
    v_mfma_f32_16x16x32_bf16 v[156:159], v[236:239], v[64:67], v[156:159]
    ds_read_b128 v[56:59], v1 offset:28672
    v_mfma_f32_16x16x32_bf16 v[160:163], v[240:243], v[64:67], v[160:163]
    s_waitcnt lgkmcnt(2)
    v_mfma_f32_16x16x32_bf16 v[164:167], v[28:31], v[68:71], v[164:167]
    ds_read_b128 v[60:63], v2 offset:22528
    v_mfma_f32_16x16x32_bf16 v[168:171], v[32:35], v[68:71], v[168:171]
    v_mfma_f32_16x16x32_bf16 v[172:175], v[28:31], v[72:75], v[172:175]
    ds_read_b128 v[64:67], v2 offset:24576
    v_cvt_pk_bf16_f32 v244, v132, v136
    v_mfma_f32_16x16x32_bf16 v[176:179], v[32:35], v[72:75], v[176:179]
    v_cvt_pk_bf16_f32 v245, v133, v137
    s_waitcnt lgkmcnt(2)
    v_mfma_f32_16x16x32_bf16 v[180:183], v[28:31], v[52:55], v[180:183]
    ds_read_b128 v[68:71], v2 offset:26624
    v_cvt_pk_bf16_f32 v246, v134, v138
    v_mfma_f32_16x16x32_bf16 v[184:187], v[32:35], v[52:55], v[184:187]
    v_cvt_pk_bf16_f32 v247, v135, v139
    v_mfma_f32_16x16x32_bf16 v[188:191], v[28:31], v[56:59], v[188:191]
    ds_read_b128 v[72:75], v2 offset:28672
    ds_write_b128 v5, v[244:247] offset:0
    v_mfma_f32_16x16x32_bf16 v[192:195], v[32:35], v[56:59], v[192:195]
    v_cvt_pk_bf16_f32 v14, v140, v144
    s_waitcnt lgkmcnt(3)
    v_mfma_f32_16x16x32_bf16 v[164:167], v[36:39], v[60:63], v[164:167]
    ds_read_b128 v[52:55], v1 offset:55296
    v_cvt_pk_bf16_f32 v15, v141, v145
    v_mfma_f32_16x16x32_bf16 v[168:171], v[40:43], v[60:63], v[168:171]
    v_cvt_pk_bf16_f32 v16, v142, v146
    v_mfma_f32_16x16x32_bf16 v[172:175], v[36:39], v[64:67], v[172:175]
    ds_read_b128 v[56:59], v1 offset:57344
    v_cvt_pk_bf16_f32 v17, v143, v147
    v_mfma_f32_16x16x32_bf16 v[176:179], v[40:43], v[64:67], v[176:179]
    ds_write_b128 v5, v[14:17] offset:4352
    s_waitcnt lgkmcnt(4)
    v_mfma_f32_16x16x32_bf16 v[180:183], v[36:39], v[68:71], v[180:183]
    ds_read_b128 v[60:63], v1 offset:59392
    v_cvt_pk_bf16_f32 v244, v148, v152
    v_mfma_f32_16x16x32_bf16 v[184:187], v[40:43], v[68:71], v[184:187]
    v_cvt_pk_bf16_f32 v245, v149, v153
    v_mfma_f32_16x16x32_bf16 v[188:191], v[36:39], v[72:75], v[188:191]
    ds_read_b128 v[64:67], v1 offset:61440
    v_cvt_pk_bf16_f32 v246, v150, v154
    v_mfma_f32_16x16x32_bf16 v[192:195], v[40:43], v[72:75], v[192:195]
    v_cvt_pk_bf16_f32 v247, v151, v155
    s_waitcnt lgkmcnt(3)
    v_mfma_f32_16x16x32_bf16 v[164:167], v[196:199], v[52:55], v[164:167]
    ds_read_b128 v[68:71], v2 offset:55296
    ds_write_b128 v5, v[244:247] offset:8704
    v_mfma_f32_16x16x32_bf16 v[168:171], v[200:203], v[52:55], v[168:171]
    v_cvt_pk_bf16_f32 v14, v156, v160
    v_mfma_f32_16x16x32_bf16 v[172:175], v[196:199], v[56:59], v[172:175]
    ds_read_b128 v[72:75], v2 offset:57344
    v_cvt_pk_bf16_f32 v15, v157, v161
    v_mfma_f32_16x16x32_bf16 v[176:179], v[200:203], v[56:59], v[176:179]
    v_cvt_pk_bf16_f32 v16, v158, v162
    s_waitcnt lgkmcnt(3)
    v_mfma_f32_16x16x32_bf16 v[180:183], v[196:199], v[60:63], v[180:183]
    ds_read_b128 v[52:55], v2 offset:59392
    v_cvt_pk_bf16_f32 v17, v159, v163
    v_mfma_f32_16x16x32_bf16 v[184:187], v[200:203], v[60:63], v[184:187]
    ds_write_b128 v5, v[14:17] offset:32768
    v_mfma_f32_16x16x32_bf16 v[188:191], v[196:199], v[64:67], v[188:191]
    ds_read_b128 v[56:59], v2 offset:61440
    v_mfma_f32_16x16x32_bf16 v[192:195], v[200:203], v[64:67], v[192:195]
    s_waitcnt lgkmcnt(0)
    s_barrier
    v_mfma_f32_16x16x32_bf16 v[164:167], v[204:207], v[68:71], v[164:167]
    ds_read_b128 v[60:63], v3 offset:22528
    v_mfma_f32_16x16x32_bf16 v[168:171], v[208:211], v[68:71], v[168:171]
    v_mfma_f32_16x16x32_bf16 v[172:175], v[204:207], v[72:75], v[172:175]
    ds_read_b128 v[64:67], v3 offset:24576
    v_mfma_f32_16x16x32_bf16 v[176:179], v[208:211], v[72:75], v[176:179]
    v_mfma_f32_16x16x32_bf16 v[180:183], v[204:207], v[52:55], v[180:183]
    ds_read_b128 v[68:71], v3 offset:26624
    v_mfma_f32_16x16x32_bf16 v[184:187], v[208:211], v[52:55], v[184:187]
    v_mfma_f32_16x16x32_bf16 v[188:191], v[204:207], v[56:59], v[188:191]
    ds_read_b128 v[72:75], v3 offset:28672
    v_mfma_f32_16x16x32_bf16 v[192:195], v[208:211], v[56:59], v[192:195]
    s_waitcnt lgkmcnt(2)
    v_mfma_f32_16x16x32_bf16 v[164:167], v[212:215], v[60:63], v[164:167]
    ds_read_b128 v[52:55], v4 offset:22528
    v_mfma_f32_16x16x32_bf16 v[168:171], v[216:219], v[60:63], v[168:171]
    v_mfma_f32_16x16x32_bf16 v[172:175], v[212:215], v[64:67], v[172:175]
    ds_read_b128 v[56:59], v4 offset:24576
    v_mfma_f32_16x16x32_bf16 v[176:179], v[216:219], v[64:67], v[176:179]
    s_waitcnt lgkmcnt(2)
    v_mfma_f32_16x16x32_bf16 v[180:183], v[212:215], v[68:71], v[180:183]
    ds_read_b128 v[60:63], v4 offset:26624
    v_mfma_f32_16x16x32_bf16 v[184:187], v[216:219], v[68:71], v[184:187]
    v_mfma_f32_16x16x32_bf16 v[188:191], v[212:215], v[72:75], v[188:191]
    ds_read_b128 v[64:67], v4 offset:28672
    v_mfma_f32_16x16x32_bf16 v[192:195], v[216:219], v[72:75], v[192:195]
    s_waitcnt lgkmcnt(2)
    v_mfma_f32_16x16x32_bf16 v[164:167], v[220:223], v[52:55], v[164:167]
    ds_read_b128 v[68:71], v3 offset:55296
    v_mfma_f32_16x16x32_bf16 v[168:171], v[224:227], v[52:55], v[168:171]
    v_mfma_f32_16x16x32_bf16 v[172:175], v[220:223], v[56:59], v[172:175]
    ds_read_b128 v[72:75], v3 offset:57344
    v_mfma_f32_16x16x32_bf16 v[176:179], v[224:227], v[56:59], v[176:179]
    s_waitcnt lgkmcnt(2)
    v_mfma_f32_16x16x32_bf16 v[180:183], v[220:223], v[60:63], v[180:183]
    ds_read_b128 v[52:55], v3 offset:59392
    v_mfma_f32_16x16x32_bf16 v[184:187], v[224:227], v[60:63], v[184:187]
    v_mfma_f32_16x16x32_bf16 v[188:191], v[220:223], v[64:67], v[188:191]
    ds_read_b128 v[56:59], v3 offset:61440
    v_mfma_f32_16x16x32_bf16 v[192:195], v[224:227], v[64:67], v[192:195]
    s_waitcnt lgkmcnt(2)
    v_mfma_f32_16x16x32_bf16 v[164:167], v[228:231], v[68:71], v[164:167]
    ds_read_b128 v[60:63], v4 offset:55296
    v_mfma_f32_16x16x32_bf16 v[168:171], v[232:235], v[68:71], v[168:171]
    v_mfma_f32_16x16x32_bf16 v[172:175], v[228:231], v[72:75], v[172:175]
    ds_read_b128 v[64:67], v4 offset:57344
    v_mfma_f32_16x16x32_bf16 v[176:179], v[232:235], v[72:75], v[176:179]
    s_waitcnt lgkmcnt(2)
    v_mfma_f32_16x16x32_bf16 v[180:183], v[228:231], v[52:55], v[180:183]
    ds_read_b128 v[68:71], v4 offset:59392
    v_mfma_f32_16x16x32_bf16 v[184:187], v[232:235], v[52:55], v[184:187]
    v_mfma_f32_16x16x32_bf16 v[188:191], v[228:231], v[56:59], v[188:191]
    ds_read_b128 v[72:75], v4 offset:61440
    v_mfma_f32_16x16x32_bf16 v[192:195], v[232:235], v[56:59], v[192:195]
    s_waitcnt lgkmcnt(2)
    v_mfma_f32_16x16x32_bf16 v[164:167], v[236:239], v[60:63], v[164:167]
    v_mfma_f32_16x16x32_bf16 v[168:171], v[240:243], v[60:63], v[168:171]
    v_mfma_f32_16x16x32_bf16 v[172:175], v[236:239], v[64:67], v[172:175]
    v_mfma_f32_16x16x32_bf16 v[176:179], v[240:243], v[64:67], v[176:179]
    s_waitcnt lgkmcnt(0)
    v_mfma_f32_16x16x32_bf16 v[180:183], v[236:239], v[68:71], v[180:183]
    v_mfma_f32_16x16x32_bf16 v[184:187], v[240:243], v[68:71], v[184:187]
    v_mfma_f32_16x16x32_bf16 v[188:191], v[236:239], v[72:75], v[188:191]
    v_mfma_f32_16x16x32_bf16 v[192:195], v[240:243], v[72:75], v[192:195]
    s_nop 7
    v_cvt_pk_bf16_f32 v52, v164, v168
    v_cvt_pk_bf16_f32 v53, v165, v169
    v_cvt_pk_bf16_f32 v54, v166, v170
    v_cvt_pk_bf16_f32 v55, v167, v171
    ds_write_b128 v5, v[52:55] offset:37120
    v_cvt_pk_bf16_f32 v56, v172, v176
    v_cvt_pk_bf16_f32 v57, v173, v177
    v_cvt_pk_bf16_f32 v58, v174, v178
    v_cvt_pk_bf16_f32 v59, v175, v179
    ds_write_b128 v5, v[56:59] offset:41472
    v_cvt_pk_bf16_f32 v60, v180, v184
    v_cvt_pk_bf16_f32 v61, v181, v185
    v_cvt_pk_bf16_f32 v62, v182, v186
    v_cvt_pk_bf16_f32 v63, v183, v187
    ds_write_b128 v8, v[60:63] offset:0
    s_nop 7
    v_cvt_pk_bf16_f32 v64, v188, v192
    v_cvt_pk_bf16_f32 v65, v189, v193
    v_cvt_pk_bf16_f32 v66, v190, v194
    v_cvt_pk_bf16_f32 v67, v191, v195
    ds_write_b128 v8, v[64:67] offset:4352
    s_branch L_store
L_dma:
    v_and_b32 v94, 63, v0
    s_and_b32 s34, s27, 3
    v_bfe_u32 v89, v0, 6, 2
    v_mov_b32 v12, 131072
    s_and_b32 s28, s27, 3
    s_lshl_b32 s29, s47, 1
    v_bfe_u32 v92, v0, 5, 1
    v_add_u32 v92, s29, v92
    v_and_b32 v90, 31, v0
    v_lshl_add_u32 v93, v92, 3, s28
    s_mov_b32 s30, 114688
    v_mul_lo_u32 v9, v93, s30
    s_lshl_b32 s30, s26, 9
    v_lshl_add_u32 v93, v90, 4, s30
    v_add_u32 v9, v9, v93
    s_lshl_b32 s30, s26, 4
    v_add_u32 v92, s30, v92
    v_lshrrev_b32 v93, 3, v90
    v_lshl_add_u32 v92, v92, 2, v93
    v_lshlrev_b32 v92, 10, v92
    v_and_b32 v93, 7, v90
    v_lshl_add_u32 v92, v93, 4, v92
    s_lshl_b32 s30, s28, 8
    v_add_u32 v10, s30, v92
    s_waitcnt lgkmcnt(0)
    s_mov_b32 s4, s36
    s_and_b32 s5, s37, 0xffff
    s_mov_b32 s6, 4194304
    s_mov_b32 s7, 0x00020000
    s_mov_b32 s48, s38
    s_and_b32 s49, s39, 0xffff
    s_mov_b32 s50, 14680064
    s_mov_b32 s51, 0x00020000
    s_mov_b32 s8, s62
    s_and_b32 s9, s63, 0xffff
    s_mov_b32 s10, 1842176
    s_mov_b32 s11, 0x00020000
    s_mov_b32 s52, s60
    s_and_b32 s53, s61, 0xffff
    s_mov_b32 s54, 256
    s_mov_b32 s55, 0x00020000
    s_cmp_lt_u32 s25, 8
    s_cselect_b32 s10, 1842176, 0
    s_mov_b32 s28, 0
    buffer_load_dwordx4 v[24:27], v9, s[48:51], s28 offen nt
    s_mov_b32 s28, 14336
    buffer_load_dwordx4 v[28:31], v9, s[48:51], s28 offen nt
    s_mov_b32 s28, 28672
    buffer_load_dwordx4 v[32:35], v9, s[48:51], s28 offen nt
    s_mov_b32 s28, 43008
    buffer_load_dwordx4 v[36:39], v9, s[48:51], s28 offen nt
    s_mov_b32 s28, 57344
    buffer_load_dwordx4 v[40:43], v9, s[48:51], s28 offen nt
    s_mov_b32 s28, 71680
    buffer_load_dwordx4 v[44:47], v9, s[48:51], s28 offen nt
    s_mov_b32 s28, 86016
    buffer_load_dwordx4 v[48:51], v9, s[48:51], s28 offen nt
    s_mov_b32 s28, 100352
    buffer_load_dwordx4 v[52:55], v9, s[48:51], s28 offen nt
    s_mov_b32 s28, 458752
    buffer_load_dwordx4 v[56:59], v9, s[48:51], s28 offen nt
    s_mov_b32 s28, 473088
    buffer_load_dwordx4 v[60:63], v9, s[48:51], s28 offen nt
    s_mov_b32 s28, 487424
    buffer_load_dwordx4 v[64:67], v9, s[48:51], s28 offen nt
    s_mov_b32 s28, 501760
    buffer_load_dwordx4 v[68:71], v9, s[48:51], s28 offen nt
    s_mov_b32 s28, 516096
    buffer_load_dwordx4 v[72:75], v9, s[48:51], s28 offen nt
    s_mov_b32 s28, 530432
    buffer_load_dwordx4 v[76:79], v9, s[48:51], s28 offen nt
    s_mov_b32 s28, 544768
    buffer_load_dwordx4 v[80:83], v9, s[48:51], s28 offen nt
    s_mov_b32 s28, 559104
    buffer_load_dwordx4 v[84:87], v9, s[48:51], s28 offen nt
    v_bfe_u32 v88, v0, 3, 3
    v_and_b32 v90, 7, v0
    v_bfe_u32 v91, v0, 4, 2
    s_mul_i32 s28, s25, 240
    v_lshl_add_u32 v92, v89, 6, v88
    v_add_u32 v92, s28, v92
    v_lshlrev_b32 v92, 11, v92
    v_xor_b32 v93, v90, v91
    v_lshl_add_u32 v1, v93, 4, v92
    v_xor_b32 v93, 4, v93
    v_lshl_add_u32 v2, v93, 4, v92
    v_add_u32 v2, 16384, v2
    v_add_u32 v3, 32768, v1
    v_add_u32 v4, 32768, v2
    v_add_u32 v5, 65536, v1
    v_add_u32 v6, 65536, v2
    v_add_u32 v7, 98304, v1
    v_add_u32 v8, 98304, v2
    v_cmp_eq_u32 vcc, 3, v89
    v_mov_b32 v92, 0x7f000000
    s_nop 0
    v_cndmask_b32 v7, v7, v92, vcc
    v_cndmask_b32 v8, v8, v92, vcc
    s_lshl_b32 s28, s26, 8
    s_lshl_b32 s29, s47, 5
    s_add_u32 s28, s28, s29
    s_lshl_b32 s29, s34, 3
    s_add_u32 s28, s28, s29
    s_add_u32 s28, s28, 1835008
    v_mov_b32 v11, s28
    s_lshl_b32 s34, s34, 13
    s_lshl_b32 s20, s47, 8
    s_mov_b32 s35, 0
    s_barrier
    s_add_u32 s29, s34, s35
    s_add_u32 m0, s29, 0
    s_nop 0
    buffer_load_dwordx4 v1, s[4:7], s20 offen lds
    s_add_u32 m0, s29, 1024
    s_nop 0
    buffer_load_dwordx4 v2, s[4:7], s20 offen lds
    s_add_u32 m0, s29, 2048
    s_nop 0
    buffer_load_dwordx4 v3, s[4:7], s20 offen lds
    s_add_u32 m0, s29, 3072
    s_nop 0
    buffer_load_dwordx4 v4, s[4:7], s20 offen lds
    s_add_u32 m0, s29, 4096
    s_nop 0
    buffer_load_dwordx4 v5, s[4:7], s20 offen lds
    s_add_u32 m0, s29, 5120
    s_nop 0
    buffer_load_dwordx4 v6, s[4:7], s20 offen lds
    s_add_u32 m0, s29, 6144
    s_nop 0
    buffer_load_dwordx4 v7, s[4:7], s20 offen lds
    s_add_u32 m0, s29, 7168
    s_nop 0
    buffer_load_dwordx4 v8, s[4:7], s20 offen lds
    s_add_u32 s20, s20, 128
    s_and_b32 s20, s20, 2047
    s_add_u32 s35, s35, 32768
    s_cmp_eq_u32 s35, 131072
    s_cselect_b32 s35, 0, s35
    s_waitcnt vmcnt(20)
    v_lshl_or_b32 v24, v28, 8, v24
    v_lshl_or_b32 v32, v36, 8, v32
    v_lshl_or_b32 v24, v32, 16, v24
    v_lshl_or_b32 v25, v29, 8, v25
    v_lshl_or_b32 v33, v37, 8, v33
    v_lshl_or_b32 v25, v33, 16, v25
    v_lshl_or_b32 v26, v30, 8, v26
    v_lshl_or_b32 v34, v38, 8, v34
    v_lshl_or_b32 v26, v34, 16, v26
    v_lshl_or_b32 v27, v31, 8, v27
    v_lshl_or_b32 v35, v39, 8, v35
    v_lshl_or_b32 v27, v35, 16, v27
    s_waitcnt vmcnt(16)
    v_lshl_or_b32 v40, v44, 8, v40
    v_lshl_or_b32 v48, v52, 8, v48
    v_lshl_or_b32 v40, v48, 16, v40
    v_lshl_or_b32 v41, v45, 8, v41
    v_lshl_or_b32 v49, v53, 8, v49
    v_lshl_or_b32 v41, v49, 16, v41
    v_lshl_or_b32 v42, v46, 8, v42
    v_lshl_or_b32 v50, v54, 8, v50
    v_lshl_or_b32 v42, v50, 16, v42
    v_lshl_or_b32 v43, v47, 8, v43
    v_lshl_or_b32 v51, v55, 8, v51
    v_lshl_or_b32 v43, v51, 16, v43
    v_lshl_or_b32 v16, v40, 4, v24
    v_lshl_or_b32 v18, v41, 4, v25
    v_lshl_or_b32 v20, v42, 4, v26
    v_lshl_or_b32 v22, v43, 4, v27
    s_waitcnt vmcnt(12)
    v_lshl_or_b32 v56, v60, 8, v56
    v_lshl_or_b32 v64, v68, 8, v64
    v_lshl_or_b32 v56, v64, 16, v56
    v_lshl_or_b32 v57, v61, 8, v57
    v_lshl_or_b32 v65, v69, 8, v65
    v_lshl_or_b32 v57, v65, 16, v57
    v_lshl_or_b32 v58, v62, 8, v58
    v_lshl_or_b32 v66, v70, 8, v66
    v_lshl_or_b32 v58, v66, 16, v58
    v_lshl_or_b32 v59, v63, 8, v59
    v_lshl_or_b32 v67, v71, 8, v67
    v_lshl_or_b32 v59, v67, 16, v59
    s_waitcnt vmcnt(8)
    v_lshl_or_b32 v72, v76, 8, v72
    v_lshl_or_b32 v80, v84, 8, v80
    v_lshl_or_b32 v72, v80, 16, v72
    v_lshl_or_b32 v73, v77, 8, v73
    v_lshl_or_b32 v81, v85, 8, v81
    v_lshl_or_b32 v73, v81, 16, v73
    v_lshl_or_b32 v74, v78, 8, v74
    v_lshl_or_b32 v82, v86, 8, v82
    v_lshl_or_b32 v74, v82, 16, v74
    v_lshl_or_b32 v75, v79, 8, v75
    v_lshl_or_b32 v83, v87, 8, v83
    v_lshl_or_b32 v75, v83, 16, v75
    v_lshl_or_b32 v17, v72, 4, v56
    v_lshl_or_b32 v19, v73, 4, v57
    v_lshl_or_b32 v21, v74, 4, v58
    v_lshl_or_b32 v23, v75, 4, v59
    buffer_store_dwordx4 v[16:19], v10, s[8:11], 0 offen sc0 sc1
    buffer_store_dwordx4 v[20:23], v10, s[8:11], 0 offen offset:128 sc0 sc1
    v_and_b32 v92, 0x1fff, v10
    v_add_u32 v92, 131136, v92
    ds_write_b128 v92, v[16:19]
    ds_write_b128 v92, v[20:23] offset:128
    s_waitcnt vmcnt(2)
    s_waitcnt lgkmcnt(0)
    s_barrier
    s_waitcnt vmcnt(0)
    v_mov_b32 v92, s56
    v_mov_b32 v93, s57
    buffer_store_dwordx2 v[92:93], v11, s[8:11], 0 offen sc0 sc1
    s_add_u32 s29, s34, s35
    s_add_u32 m0, s29, 0
    s_nop 0
    buffer_load_dwordx4 v1, s[4:7], s20 offen lds
    s_add_u32 m0, s29, 1024
    s_nop 0
    buffer_load_dwordx4 v2, s[4:7], s20 offen lds
    s_add_u32 m0, s29, 2048
    s_nop 0
    buffer_load_dwordx4 v3, s[4:7], s20 offen lds
    s_add_u32 m0, s29, 3072
    s_nop 0
    buffer_load_dwordx4 v4, s[4:7], s20 offen lds
    s_add_u32 m0, s29, 4096
    s_nop 0
    buffer_load_dwordx4 v5, s[4:7], s20 offen lds
    s_add_u32 m0, s29, 5120
    s_nop 0
    buffer_load_dwordx4 v6, s[4:7], s20 offen lds
    s_add_u32 m0, s29, 6144
    s_nop 0
    buffer_load_dwordx4 v7, s[4:7], s20 offen lds
    s_add_u32 m0, s29, 7168
    s_nop 0
    buffer_load_dwordx4 v8, s[4:7], s20 offen lds
    s_add_u32 s20, s20, 128
    s_and_b32 s20, s20, 2047
    s_add_u32 s35, s35, 32768
    s_cmp_eq_u32 s35, 131072
    s_cselect_b32 s35, 0, s35
    s_add_u32 s29, s34, s35
    s_add_u32 m0, s29, 0
    s_nop 0
    buffer_load_dwordx4 v1, s[4:7], s20 offen lds
    s_add_u32 m0, s29, 1024
    s_nop 0
    buffer_load_dwordx4 v2, s[4:7], s20 offen lds
    s_add_u32 m0, s29, 2048
    s_nop 0
    buffer_load_dwordx4 v3, s[4:7], s20 offen lds
    s_add_u32 m0, s29, 3072
    s_nop 0
    buffer_load_dwordx4 v4, s[4:7], s20 offen lds
    s_add_u32 m0, s29, 4096
    s_nop 0
    buffer_load_dwordx4 v5, s[4:7], s20 offen lds
    s_add_u32 m0, s29, 5120
    s_nop 0
    buffer_load_dwordx4 v6, s[4:7], s20 offen lds
    s_add_u32 m0, s29, 6144
    s_nop 0
    buffer_load_dwordx4 v7, s[4:7], s20 offen lds
    s_add_u32 m0, s29, 7168
    s_nop 0
    buffer_load_dwordx4 v8, s[4:7], s20 offen lds
    s_add_u32 s20, s20, 128
    s_and_b32 s20, s20, 2047
    s_add_u32 s35, s35, 32768
    s_cmp_eq_u32 s35, 131072
    s_cselect_b32 s35, 0, s35
    s_mov_b32 s44, 0
    s_add_u32 s44, s44, 1
    s_add_u32 s29, s34, s35
    s_add_u32 m0, s29, 0
    s_nop 0
    buffer_load_dwordx4 v1, s[4:7], s20 offen lds
    s_add_u32 m0, s29, 1024
    s_nop 0
    buffer_load_dwordx4 v2, s[4:7], s20 offen lds
    s_add_u32 m0, s29, 2048
    s_nop 0
    buffer_load_dwordx4 v3, s[4:7], s20 offen lds
    s_add_u32 m0, s29, 3072
    s_nop 0
    buffer_load_dwordx4 v4, s[4:7], s20 offen lds
    s_add_u32 m0, s29, 4096
    s_nop 0
    buffer_load_dwordx4 v5, s[4:7], s20 offen lds
    s_add_u32 m0, s29, 5120
    s_nop 0
    buffer_load_dwordx4 v6, s[4:7], s20 offen lds
    s_add_u32 m0, s29, 6144
    s_nop 0
    buffer_load_dwordx4 v7, s[4:7], s20 offen lds
    s_add_u32 m0, s29, 7168
    s_nop 0
    buffer_load_dwordx4 v8, s[4:7], s20 offen lds
    s_add_u32 s20, s20, 128
    s_and_b32 s20, s20, 2047
    s_add_u32 s35, s35, 32768
    s_cmp_eq_u32 s35, 131072
    s_cselect_b32 s35, 0, s35
    s_waitcnt vmcnt(16)
    s_barrier
    s_add_u32 s44, s44, 1
    s_add_u32 s29, s34, s35
    s_add_u32 m0, s29, 0
    s_nop 0
    buffer_load_dwordx4 v1, s[4:7], s20 offen lds
    s_add_u32 m0, s29, 1024
    s_nop 0
    buffer_load_dwordx4 v2, s[4:7], s20 offen lds
    s_add_u32 m0, s29, 2048
    s_nop 0
    buffer_load_dwordx4 v3, s[4:7], s20 offen lds
    s_add_u32 m0, s29, 3072
    s_nop 0
    buffer_load_dwordx4 v4, s[4:7], s20 offen lds
    s_add_u32 m0, s29, 4096
    s_nop 0
    buffer_load_dwordx4 v5, s[4:7], s20 offen lds
    s_add_u32 m0, s29, 5120
    s_nop 0
    buffer_load_dwordx4 v6, s[4:7], s20 offen lds
    s_add_u32 m0, s29, 6144
    s_nop 0
    buffer_load_dwordx4 v7, s[4:7], s20 offen lds
    s_add_u32 m0, s29, 7168
    s_nop 0
    buffer_load_dwordx4 v8, s[4:7], s20 offen lds
    s_add_u32 s20, s20, 128
    s_and_b32 s20, s20, 2047
    s_add_u32 s35, s35, 32768
    s_cmp_eq_u32 s35, 131072
    s_cselect_b32 s35, 0, s35
    s_waitcnt vmcnt(16)
    s_barrier
    s_barrier
    ds_read_b32 v92, v12 offset:8
    s_waitcnt lgkmcnt(0)
    v_readfirstlane_b32 s59, v92
    s_cmp_eq_u32 s59, 0
    s_cbranch_scc1 L_hgo
    s_mov_b32 s10, 1842176
    s_mov_b32 s47, 0
    s_waitcnt vmcnt(0)
L_fbk:
    s_and_b32 s28, s27, 3
    s_lshl_b32 s29, s47, 1
    v_bfe_u32 v92, v0, 5, 1
    v_add_u32 v92, s29, v92
    v_and_b32 v90, 31, v0
    v_lshl_add_u32 v93, v92, 3, s28
    s_mov_b32 s30, 114688
    v_mul_lo_u32 v9, v93, s30
    s_lshl_b32 s30, s26, 9
    v_lshl_add_u32 v93, v90, 4, s30
    v_add_u32 v9, v9, v93
    s_lshl_b32 s30, s26, 4
    v_add_u32 v92, s30, v92
    v_lshrrev_b32 v93, 3, v90
    v_lshl_add_u32 v92, v92, 2, v93
    v_lshlrev_b32 v92, 10, v92
    v_and_b32 v93, 7, v90
    v_lshl_add_u32 v92, v93, 4, v92
    s_lshl_b32 s30, s28, 8
    v_add_u32 v10, s30, v92
    s_mov_b32 s28, 0
    buffer_load_dwordx4 v[24:27], v9, s[48:51], s28 offen nt
    s_mov_b32 s28, 14336
    buffer_load_dwordx4 v[28:31], v9, s[48:51], s28 offen nt
    s_mov_b32 s28, 28672
    buffer_load_dwordx4 v[32:35], v9, s[48:51], s28 offen nt
    s_mov_b32 s28, 43008
    buffer_load_dwordx4 v[36:39], v9, s[48:51], s28 offen nt
    s_mov_b32 s28, 57344
    buffer_load_dwordx4 v[40:43], v9, s[48:51], s28 offen nt
    s_mov_b32 s28, 71680
    buffer_load_dwordx4 v[44:47], v9, s[48:51], s28 offen nt
    s_mov_b32 s28, 86016
    buffer_load_dwordx4 v[48:51], v9, s[48:51], s28 offen nt
    s_mov_b32 s28, 100352
    buffer_load_dwordx4 v[52:55], v9, s[48:51], s28 offen nt
    s_mov_b32 s28, 458752
    buffer_load_dwordx4 v[56:59], v9, s[48:51], s28 offen nt
    s_mov_b32 s28, 473088
    buffer_load_dwordx4 v[60:63], v9, s[48:51], s28 offen nt
    s_mov_b32 s28, 487424
    buffer_load_dwordx4 v[64:67], v9, s[48:51], s28 offen nt
    s_mov_b32 s28, 501760
    buffer_load_dwordx4 v[68:71], v9, s[48:51], s28 offen nt
    s_mov_b32 s28, 516096
    buffer_load_dwordx4 v[72:75], v9, s[48:51], s28 offen nt
    s_mov_b32 s28, 530432
    buffer_load_dwordx4 v[76:79], v9, s[48:51], s28 offen nt
    s_mov_b32 s28, 544768
    buffer_load_dwordx4 v[80:83], v9, s[48:51], s28 offen nt
    s_mov_b32 s28, 559104
    buffer_load_dwordx4 v[84:87], v9, s[48:51], s28 offen nt
    s_waitcnt vmcnt(12)
    v_lshl_or_b32 v24, v28, 8, v24
    v_lshl_or_b32 v32, v36, 8, v32
    v_lshl_or_b32 v24, v32, 16, v24
    v_lshl_or_b32 v25, v29, 8, v25
    v_lshl_or_b32 v33, v37, 8, v33
    v_lshl_or_b32 v25, v33, 16, v25
    v_lshl_or_b32 v26, v30, 8, v26
    v_lshl_or_b32 v34, v38, 8, v34
    v_lshl_or_b32 v26, v34, 16, v26
    v_lshl_or_b32 v27, v31, 8, v27
    v_lshl_or_b32 v35, v39, 8, v35
    v_lshl_or_b32 v27, v35, 16, v27
    s_waitcnt vmcnt(8)
    v_lshl_or_b32 v40, v44, 8, v40
    v_lshl_or_b32 v48, v52, 8, v48
    v_lshl_or_b32 v40, v48, 16, v40
    v_lshl_or_b32 v41, v45, 8, v41
    v_lshl_or_b32 v49, v53, 8, v49
    v_lshl_or_b32 v41, v49, 16, v41
    v_lshl_or_b32 v42, v46, 8, v42
    v_lshl_or_b32 v50, v54, 8, v50
    v_lshl_or_b32 v42, v50, 16, v42
    v_lshl_or_b32 v43, v47, 8, v43
    v_lshl_or_b32 v51, v55, 8, v51
    v_lshl_or_b32 v43, v51, 16, v43
    v_lshl_or_b32 v16, v40, 4, v24
    v_lshl_or_b32 v18, v41, 4, v25
    v_lshl_or_b32 v20, v42, 4, v26
    v_lshl_or_b32 v22, v43, 4, v27
    s_waitcnt vmcnt(4)
    v_lshl_or_b32 v56, v60, 8, v56
    v_lshl_or_b32 v64, v68, 8, v64
    v_lshl_or_b32 v56, v64, 16, v56
    v_lshl_or_b32 v57, v61, 8, v57
    v_lshl_or_b32 v65, v69, 8, v65
    v_lshl_or_b32 v57, v65, 16, v57
    v_lshl_or_b32 v58, v62, 8, v58
    v_lshl_or_b32 v66, v70, 8, v66
    v_lshl_or_b32 v58, v66, 16, v58
    v_lshl_or_b32 v59, v63, 8, v59
    v_lshl_or_b32 v67, v71, 8, v67
    v_lshl_or_b32 v59, v67, 16, v59
    s_waitcnt vmcnt(0)
    v_lshl_or_b32 v72, v76, 8, v72
    v_lshl_or_b32 v80, v84, 8, v80
    v_lshl_or_b32 v72, v80, 16, v72
    v_lshl_or_b32 v73, v77, 8, v73
    v_lshl_or_b32 v81, v85, 8, v81
    v_lshl_or_b32 v73, v81, 16, v73
    v_lshl_or_b32 v74, v78, 8, v74
    v_lshl_or_b32 v82, v86, 8, v82
    v_lshl_or_b32 v74, v82, 16, v74
    v_lshl_or_b32 v75, v79, 8, v75
    v_lshl_or_b32 v83, v87, 8, v83
    v_lshl_or_b32 v75, v83, 16, v75
    v_lshl_or_b32 v17, v72, 4, v56
    v_lshl_or_b32 v19, v73, 4, v57
    v_lshl_or_b32 v21, v74, 4, v58
    v_lshl_or_b32 v23, v75, 4, v59
    buffer_store_dwordx4 v[16:19], v10, s[8:11], 0 offen sc0 sc1
    buffer_store_dwordx4 v[20:23], v10, s[8:11], 0 offen offset:128 sc0 sc1
    s_waitcnt vmcnt(0)
    s_add_u32 s47, s47, 1
    s_cmp_lt_u32 s47, 8
    s_cbranch_scc1 L_fbk
    s_barrier
L_hgo:
L_dloop:
    s_add_u32 s44, s44, 1
    s_add_u32 s29, s34, s35
    s_add_u32 m0, s29, 0
    s_nop 0
    buffer_load_dwordx4 v1, s[4:7], s20 offen lds
    s_add_u32 m0, s29, 1024
    s_nop 0
    buffer_load_dwordx4 v2, s[4:7], s20 offen lds
    s_add_u32 m0, s29, 2048
    s_nop 0
    buffer_load_dwordx4 v3, s[4:7], s20 offen lds
    s_add_u32 m0, s29, 3072
    s_nop 0
    buffer_load_dwordx4 v4, s[4:7], s20 offen lds
    s_add_u32 m0, s29, 4096
    s_nop 0
    buffer_load_dwordx4 v5, s[4:7], s20 offen lds
    s_add_u32 m0, s29, 5120
    s_nop 0
    buffer_load_dwordx4 v6, s[4:7], s20 offen lds
    s_add_u32 m0, s29, 6144
    s_nop 0
    buffer_load_dwordx4 v7, s[4:7], s20 offen lds
    s_add_u32 m0, s29, 7168
    s_nop 0
    buffer_load_dwordx4 v8, s[4:7], s20 offen lds
    s_add_u32 s20, s20, 128
    s_and_b32 s20, s20, 2047
    s_add_u32 s35, s35, 32768
    s_cmp_eq_u32 s35, 131072
    s_cselect_b32 s35, 0, s35
    s_waitcnt vmcnt(16)
    s_barrier
    s_cmp_lt_u32 s44, 13
    s_cbranch_scc1 L_dloop
    s_waitcnt vmcnt(8)
    s_barrier
    s_waitcnt vmcnt(0)
    s_barrier
    s_mov_b32 s16, s42
    s_and_b32 s17, s43, 0xffff
    s_mov_b32 s18, 14680064
    s_mov_b32 s19, 0x00020000
    s_and_b32 s28, s27, 3
    s_mul_i32 s28, s28, 28
    s_mul_i32 s30, s28, 272
    s_add_u32 s30, s30, 131136
    s_mul_i32 s31, s25, 240
    s_add_u32 s31, s31, s28
    s_mul_i32 s31, s31, 7168
    s_lshl_b32 s29, s26, 8
    s_add_u32 s45, s31, s29
    s_mov_b32 s29, 7168
    v_bfe_u32 v100, v0, 4, 2
    v_and_b32 v101, 15, v0
    v_lshlrev_b32 v101, 4, v101
    v_mul_u32_u24 v102, 272, v100
    v_add3_u32 v102, v102, v101, s30
    v_mad_u32_u24 v103, v100, s29, v101
    s_barrier
    ds_read_b128 v[16:19], v102 offset:0
    ds_read_b128 v[20:23], v102 offset:1088
    ds_read_b128 v[24:27], v102 offset:2176
    ds_read_b128 v[28:31], v102 offset:3264
    ds_read_b128 v[32:35], v102 offset:4352
    ds_read_b128 v[36:39], v102 offset:5440
    ds_read_b128 v[40:43], v102 offset:6528
    s_waitcnt lgkmcnt(6)
    buffer_store_dwordx4 v[16:19], v103, s[16:19], s45 offen nt
    s_add_u32 s45, s45, 28672
    s_waitcnt lgkmcnt(5)
    buffer_store_dwordx4 v[20:23], v103, s[16:19], s45 offen nt
    s_add_u32 s45, s45, 28672
    s_waitcnt lgkmcnt(4)
    buffer_store_dwordx4 v[24:27], v103, s[16:19], s45 offen nt
    s_add_u32 s45, s45, 28672
    s_waitcnt lgkmcnt(3)
    buffer_store_dwordx4 v[28:31], v103, s[16:19], s45 offen nt
    s_add_u32 s45, s45, 28672
    s_waitcnt lgkmcnt(2)
    buffer_store_dwordx4 v[32:35], v103, s[16:19], s45 offen nt
    s_add_u32 s45, s45, 28672
    s_waitcnt lgkmcnt(1)
    buffer_store_dwordx4 v[36:39], v103, s[16:19], s45 offen nt
    s_add_u32 s45, s45, 28672
    s_waitcnt lgkmcnt(0)
    buffer_store_dwordx4 v[40:43], v103, s[16:19], s45 offen nt
    s_add_u32 s45, s45, 28672
    s_and_b32 s32, s27, 3
    s_mul_i32 s28, s32, 43
    s_lshr_b32 s28, s28, 7
    s_mul_i32 s29, s28, 3
    s_sub_u32 s29, s32, s29
    s_lshl_b32 s30, s28, 15
    s_mul_i32 s29, s29, 4352
    s_add_u32 s30, s30, s29
    s_mul_i32 s31, s25, 240
    s_lshl_b32 s28, s32, 4
    s_add_u32 s31, s31, s28
    s_add_u32 s31, s31, 112
    s_mul_i32 s31, s31, 7168
    s_lshl_b32 s29, s26, 8
    s_add_u32 s45, s31, s29
    s_mov_b32 s29, 7168
    v_bfe_u32 v100, v0, 4, 2
    v_and_b32 v101, 15, v0
    v_lshlrev_b32 v101, 4, v101
    v_mul_u32_u24 v102, 272, v100
    v_add3_u32 v102, v102, v101, s30
    v_mad_u32_u24 v103, v100, s29, v101
    s_barrier
    ds_read_b128 v[64:67], v102 offset:0
    ds_read_b128 v[68:71], v102 offset:1088
    ds_read_b128 v[72:75], v102 offset:2176
    ds_read_b128 v[76:79], v102 offset:3264
    s_waitcnt lgkmcnt(3)
    buffer_store_dwordx4 v[64:67], v103, s[16:19], s45 offen nt
    s_add_u32 s45, s45, 28672
    s_waitcnt lgkmcnt(2)
    buffer_store_dwordx4 v[68:71], v103, s[16:19], s45 offen nt
    s_add_u32 s45, s45, 28672
    s_waitcnt lgkmcnt(1)
    buffer_store_dwordx4 v[72:75], v103, s[16:19], s45 offen nt
    s_add_u32 s45, s45, 28672
    s_waitcnt lgkmcnt(0)
    buffer_store_dwordx4 v[76:79], v103, s[16:19], s45 offen nt
    s_add_u32 s45, s45, 28672
L_store:
    s_mov_b32 s16, s42
    s_and_b32 s17, s43, 0xffff
    s_mov_b32 s18, 14680064
    s_mov_b32 s19, 0x00020000
    s_lshr_b32 s32, s27, 1
    s_add_u32 s32, s32, 4
    s_mul_i32 s28, s32, 43
    s_lshr_b32 s28, s28, 7
    s_mul_i32 s29, s28, 3
    s_sub_u32 s29, s32, s29
    s_lshl_b32 s30, s28, 15
    s_mul_i32 s29, s29, 4352
    s_add_u32 s30, s30, s29
    s_mul_i32 s31, s25, 240
    s_lshl_b32 s28, s32, 4
    s_add_u32 s31, s31, s28
    s_add_u32 s31, s31, 112
    s_mul_i32 s31, s31, 7168
    s_lshl_b32 s29, s26, 8
    s_add_u32 s45, s31, s29
    s_mov_b32 s29, 7168
    v_bfe_u32 v100, v0, 4, 2
    v_and_b32 v101, 15, v0
    v_lshlrev_b32 v101, 4, v101
    v_mul_u32_u24 v102, 272, v100
    v_add3_u32 v102, v102, v101, s30
    v_mad_u32_u24 v103, v100, s29, v101
    s_and_b32 s28, s27, 1
    s_mul_i32 s29, s28, 2176
    v_add_u32 v102, s29, v102
    s_mul_i32 s29, s28, 57344
    s_add_u32 s45, s45, s29
    s_waitcnt lgkmcnt(0)
    s_barrier
    ds_read_b128 v[48:51], v102 offset:0
    ds_read_b128 v[52:55], v102 offset:1088
    s_waitcnt lgkmcnt(1)
    buffer_store_dwordx4 v[48:51], v103, s[16:19], s45 offen nt
    s_add_u32 s45, s45, 28672
    s_waitcnt lgkmcnt(0)
    buffer_store_dwordx4 v[52:55], v103, s[16:19], s45 offen nt
    s_add_u32 s45, s45, 28672
L_end:
    s_endpgm
.section .rodata,"a"
.p2align 6
.amdhsa_kernel standalone__weight_only_int_squeezellm__prompt_kernel
  .amdhsa_next_free_vgpr 252
  .amdhsa_next_free_sgpr 100
  .amdhsa_accum_offset 252
  .amdhsa_group_segment_fixed_size 0
  .amdhsa_kernarg_size 48
  .amdhsa_user_sgpr_count 2
  .amdhsa_user_sgpr_kernarg_segment_ptr 1
  .amdhsa_system_sgpr_workgroup_id_x 1
.end_amdhsa_kernel
```
